```python
import torch

def _softmax(x, axis=-1):
    return torch.softmax(x, dim=axis)
def _gelu(x):
    return torch.nn.functional.gelu(x, approximate="tanh")
def _silu(x):
    return torch.nn.functional.silu(x)
def _sigmoid(x):
    return torch.sigmoid(x)
def _layernorm(x, axis=-1, eps=1e-5):
    m = x.mean(dim=axis, keepdim=True)
    v = x.var(dim=axis, keepdim=True, unbiased=False)
    return (x - m) / torch.sqrt(v + eps)
def _scatter_add(tgt, idx, src, axis=0):
    return tgt.clone().index_add_(axis, idx, src)
def _segment_sum(src, seg, n):
    out = torch.zeros((n,) + src.shape[1:], dtype=src.dtype)
    return out.index_add_(0, seg, src)
def _pad(x, pw):
    flat = tuple(v for pair in reversed(pw) for v in pair)
    return torch.nn.functional.pad(x, flat)

kernel_name = 'sequential_preLN__softmax_full_mha__dense_activation_relu__prompt'

def setup_inputs():

    _w = (lambda a: (lambda t: t.to(torch.bfloat16) if t.is_floating_point() else t)(torch.as_tensor(a)))
    def _A_setup():
        B, S, D = 1, 2048, 512
        return {
            "x": _w((lambda *s: torch.randn(*s, dtype=torch.bfloat16) * 0.05)(B, S, D)),
            "wqkv": _w((lambda *s: torch.randn(*s, dtype=torch.bfloat16) * 0.05)(D, 3 * D)),
            "wo": _w((lambda *s: torch.randn(*s, dtype=torch.bfloat16) * 0.05)(D, D)),
        }
    _A_in = _A_setup()

    def _B_setup():
        B, S, D, Dff = 1, 2048, 512, 1792
        return {
            "x": _w((lambda *s: torch.randn(*s, dtype=torch.bfloat16) * 0.05)(B, S, D)),
            "w1": _w((lambda *s: torch.randn(*s, dtype=torch.bfloat16) * 0.05)(D, Dff)),
            "w2": _w((lambda *s: torch.randn(*s, dtype=torch.bfloat16) * 0.05)(Dff, D)),
        }
    _B_in = _B_setup()

    return {
        "A_x": _A_in["x"],
        "A_wqkv": _A_in["wqkv"],
        "A_wo": _A_in["wo"],
        "B_x": _B_in["x"],
        "B_w1": _B_in["w1"],
        "B_w2": _B_in["w2"],
    }

def reference(A_x, A_wqkv, A_wo, B_x, B_w1, B_w2):
    def _A_ref(x, wqkv, wo):
        B, S, D = x.shape
        H = 32; Dh = D // H
        qkv = (lambda x, *d: x.permute(*d))((x @ wqkv).reshape(B, S, 3, H, Dh), 2, 0, 3, 1, 4)
        q, k, v = qkv[0], qkv[1], qkv[2]
        scale = Dh ** -0.5
        scores = torch.einsum("bhqd,bhkd->bhqk", q, k) * scale
        p = _softmax(scores, axis=-1)
        o = torch.einsum("bhqk,bhkd->bhqd", p, v)
        return (lambda x, *d: x.permute(*d))(o, 0, 2, 1, 3).reshape(B, S, D) @ wo

    def _B_ref(x, w1, w2):
        h = torch.einsum("bsd,df->bsf", x, w1)
        zero = torch.zeros_like(h)
        h = torch.maximum(h, zero)
        return torch.einsum("bsf,fd->bsd", h, w2)

    x = A_x
    h = x + _A_ref(_layernorm(x, axis=-1), A_wqkv, A_wo)
    h2 = h + _B_ref(_layernorm(h, axis=-1), B_w1, B_w2)
    return h2
```

```asm
; @launch grid=(256,1,1) block=(512,1,1) lds=163840
.amdgcn_target "amdgcn-amd-amdhsa--gfx950"
.text
.globl sequential_preLN__softmax_full_mha__dense_activation_relu__prompt_kernel
.p2align 8
.type sequential_preLN__softmax_full_mha__dense_activation_relu__prompt_kernel,@function
sequential_preLN__softmax_full_mha__dense_activation_relu__prompt_kernel:
  s_cmp_ge_u32 s2, 0x100
  s_cbranch_scc1 k6_kernel_end1
  s_load_dwordx2 s[4:5], s[0:1], 56
  v_mov_b32 v248, 0
  s_load_dwordx2 s[12:13], s[0:1], 0
  s_load_dwordx2 s[16:17], s[0:1], 8
  s_load_dwordx2 s[20:21], s[0:1], 64
  v_lshrrev_b32 v2, 6, v0
  v_and_b32 v1, 63, v0
  v_readfirstlane_b32 s6, v2
  s_and_b32 s8, s2, 3
  s_lshl_b32 s8, s8, 2
  s_bfe_u32 s9, s2, 0x20003
  s_or_b32 s11, s8, s9
  s_bfe_u32 s8, s2, 0x10002
  s_lshl_b32 s8, s8, 3
  s_lshr_b32 s9, s2, 5
  s_or_b32 s10, s8, s9
  s_lshl_b32 s3, s10, 4
  s_add_u32 s3, s3, s11
  s_and_b32 s7, s6, 3
  s_lshl_b32 s11, s11, 2
  s_add_u32 s11, s11, s7
  s_lshl_b32 s25, s7, 12
  s_add_u32 s25, s25, 0x14000
  s_mul_i32 s26, s7, 0xc000
  s_mul_i32 s27, s7, 0xc00
  s_mov_b32 s14, 0x200000
  s_mov_b32 s15, 0x20000
  s_mov_b32 s18, 0x180000
  s_mov_b32 s19, 0x20000
  s_mov_b32 s22, 0xc00000
  s_mov_b32 s23, 0x20000
  s_mov_b32 s28, 0
  s_cmp_gt_u32 s6, 3
  s_cbranch_scc1 k6_kernel_helper3
  s_lshl_b32 s9, s10, 6
  v_add_u32 v2, 0, v1
  v_mul_u32_u24 v3, 0xab, v2
  v_lshrrev_b32 v3, 11, v3
  v_mul_u32_u24 v4, 12, v3
  v_sub_u32 v2, v2, v4
  v_mul_u32_u24 v3, 0xc00, v3
  v_lshrrev_b32 v4, 2, v2
  v_lshl_add_u32 v3, v4, 10, v3
  v_and_b32 v2, 3, v2
  v_lshl_add_u32 v3, v2, 4, v3
  v_add_u32 v5, s9, v3
  v_add_u32 v2, 64, v1
  v_mul_u32_u24 v3, 0xab, v2
  v_lshrrev_b32 v3, 11, v3
  v_mul_u32_u24 v4, 12, v3
  v_sub_u32 v2, v2, v4
  v_mul_u32_u24 v3, 0xc00, v3
  v_lshrrev_b32 v4, 2, v2
  v_lshl_add_u32 v3, v4, 10, v3
  v_and_b32 v2, 3, v2
  v_lshl_add_u32 v3, v2, 4, v3
  v_add_u32 v6, s9, v3
  v_subrev_u32 v6, 0x400, v6
  v_add_u32 v2, 0x80, v1
  v_mul_u32_u24 v3, 0xab, v2
  v_lshrrev_b32 v3, 11, v3
  v_mul_u32_u24 v4, 12, v3
  v_sub_u32 v2, v2, v4
  v_mul_u32_u24 v3, 0xc00, v3
  v_lshrrev_b32 v4, 2, v2
  v_lshl_add_u32 v3, v4, 10, v3
  v_and_b32 v2, 3, v2
  v_lshl_add_u32 v3, v2, 4, v3
  v_add_u32 v7, s9, v3
  v_subrev_u32 v7, 0x800, v7
  s_waitcnt lgkmcnt(0)
  s_add_u32 m0, s27, 0
  s_add_u32 s8, s28, 0
  s_and_b32 s8, s8, 7
  s_mul_i32 s8, s8, 0x30000
  s_add_u32 s8, s8, s26
  buffer_load_dwordx4 v5, s[16:19], s8 offen offset:0 lds
  buffer_load_dwordx4 v6, s[16:19], s8 offen offset:1024 lds
  buffer_load_dwordx4 v7, s[16:19], s8 offen offset:2048 lds
  s_add_u32 m0, s27, 0x3000
  s_add_u32 s8, s28, 1
  s_and_b32 s8, s8, 7
  s_mul_i32 s8, s8, 0x30000
  s_add_u32 s8, s8, s26
  buffer_load_dwordx4 v5, s[16:19], s8 offen offset:0 lds
  buffer_load_dwordx4 v6, s[16:19], s8 offen offset:1024 lds
  buffer_load_dwordx4 v7, s[16:19], s8 offen offset:2048 lds
  s_add_u32 m0, s27, 0x6000
  s_add_u32 s8, s28, 2
  s_and_b32 s8, s8, 7
  s_mul_i32 s8, s8, 0x30000
  s_add_u32 s8, s8, s26
  buffer_load_dwordx4 v5, s[16:19], s8 offen offset:0 lds
  buffer_load_dwordx4 v6, s[16:19], s8 offen offset:1024 lds
  buffer_load_dwordx4 v7, s[16:19], s8 offen offset:2048 lds
  s_setprio 2
  s_lshl_b32 s8, s2, 9
  s_lshl_b32 s9, s6, 7
  s_add_u32 s8, s8, s9
  s_add_u32 s8, s8, 0xb00000
  v_and_b32 v2, 31, v1
  v_lshlrev_b32 v2, 2, v2
  v_mov_b32 v3, 0
  s_mov_b32 exec_hi, 0
  buffer_store_dword v3, v2, s[20:23], s8 offen sc1
  s_mov_b64 exec, -1
  s_lshl_b32 s8, s3, 7
  s_lshl_b32 s9, s7, 2
  s_add_u32 s8, s8, s9
  s_add_u32 s8, s8, 0xa00000
  v_mov_b32 v250, s8
  buffer_load_dword v251, v250, s[20:23], 0 offen sc1
  v_and_b32 v13, 31, v1
  v_lshrrev_b32 v14, 5, v1
  v_bfe_u32 v2, v1, 1, 3
  v_xor_b32 v2, v2, v14
  v_lshlrev_b32 v2, 4, v2
  v_lshl_or_b32 v2, v13, 7, v2
  v_add_u32 v8, s25, v2
  v_xor_b32 v9, 32, v8
  v_xor_b32 v10, 64, v8
  v_xor_b32 v11, 0x60, v8
  v_bfe_u32 v2, v1, 2, 2
  v_lshl_add_u32 v2, v14, 3, v2
  v_mul_u32_u24 v2, 0xc0, v2
  v_bfe_u32 v3, v1, 4, 1
  v_lshl_add_u32 v2, v3, 5, v2
  v_and_b32 v4, 3, v1
  v_lshl_add_u32 v12, v4, 3, v2
  v_add_u32 v189, 0xc000, v12
  v_mov_b32 v140, 0
  v_mov_b32 v141, 0
  v_lshlrev_b32 v15, 3, v13
  v_add_u32 v15, 0x12000, v15
  s_lshl_b32 s8, s7, 7
  s_add_u32 s8, s8, 0x12400
  v_lshl_add_u32 v188, v13, 2, s8
  v_lshl_add_u32 v4, v14, 4, s8
  s_lshl_b32 s8, s10, 17
  s_lshl_b32 s9, s11, 10
  s_add_u32 s8, s8, s9
  v_lshl_add_u32 v142, v1, 4, s8
  v_and_b32 v143, 15, v1
  v_lshlrev_b32 v143, 4, v143
  v_lshl_add_u32 v143, v14, 8, v143
  v_bfe_u32 v2, v1, 4, 1
  v_lshl_add_u32 v143, v2, 16, v143
  v_add_u32 v143, s8, v143
  s_mov_b32 s24, 0x10000
  s_mov_b32 s26, 0x200000
  s_mov_b32 s27, 0x210000
  s_mov_b32 s9, 0x400000
  s_waitcnt vmcnt(8)
  s_barrier
  ds_read_b128 v[16:19], v8 offset:0
  ds_read_b128 v[20:23], v9 offset:0
  ds_read_b128 v[24:27], v10 offset:0
  ds_read_b128 v[28:31], v11 offset:0
  ds_read_b64_tr_b16 v[48:49], v12 offset:0
  ds_read_b64_tr_b16 v[50:51], v12 offset:768
  ds_read_b64_tr_b16 v[52:53], v12 offset:64
  ds_read_b64_tr_b16 v[54:55], v12 offset:832
  ds_read_b64_tr_b16 v[56:57], v12 offset:128
  ds_read_b64_tr_b16 v[58:59], v12 offset:896
  ds_read_b64_tr_b16 v[60:61], v12 offset:3072
  ds_read_b64_tr_b16 v[62:63], v12 offset:3840
  ds_read_b64_tr_b16 v[64:65], v12 offset:3136
  ds_read_b64_tr_b16 v[66:67], v12 offset:3904
  ds_read_b64_tr_b16 v[68:69], v12 offset:3200
  ds_read_b64_tr_b16 v[70:71], v12 offset:3968
  s_waitcnt lgkmcnt(10)
  v_mfma_f32_32x32x16_bf16 v[84:99], v[48:51], v[16:19], 0
  ds_read_b64_tr_b16 v[72:73], v12 offset:6144
  ds_read_b64_tr_b16 v[74:75], v12 offset:6912
  s_waitcnt lgkmcnt(10)
  v_mfma_f32_32x32x16_bf16 v[100:115], v[52:55], v[16:19], 0
  ds_read_b64_tr_b16 v[76:77], v12 offset:6208
  ds_read_b64_tr_b16 v[78:79], v12 offset:6976
  s_waitcnt lgkmcnt(10)
  v_mfma_f32_32x32x16_bf16 v[116:131], v[16:19], v[56:59], 0
  ds_read_b64_tr_b16 v[80:81], v12 offset:6272
  ds_read_b64_tr_b16 v[82:83], v12 offset:7040
  s_waitcnt lgkmcnt(10)
  v_mfma_f32_32x32x16_bf16 v[84:99], v[60:63], v[20:23], v[84:99]
  ds_read_b64_tr_b16 v[48:49], v12 offset:9216
  ds_read_b64_tr_b16 v[50:51], v12 offset:9984
  s_waitcnt lgkmcnt(10)
  v_mfma_f32_32x32x16_bf16 v[100:115], v[64:67], v[20:23], v[100:115]
  ds_read_b64_tr_b16 v[52:53], v12 offset:9280
  ds_read_b64_tr_b16 v[54:55], v12 offset:10048
  s_waitcnt lgkmcnt(10)
  v_mfma_f32_32x32x16_bf16 v[116:131], v[20:23], v[68:71], v[116:131]
  ds_read_b64_tr_b16 v[56:57], v12 offset:9344
  ds_read_b64_tr_b16 v[58:59], v12 offset:10112
  s_waitcnt lgkmcnt(10)
  v_mfma_f32_32x32x16_bf16 v[84:99], v[72:75], v[24:27], v[84:99]
  s_waitcnt vmcnt(5)
  s_barrier
  ds_read_b128 v[32:35], v8 offset:16384
  ds_read_b128 v[36:39], v9 offset:16384
  ds_read_b128 v[40:43], v10 offset:16384
  ds_read_b128 v[44:47], v11 offset:16384
  ds_read_b64_tr_b16 v[60:61], v12 offset:12288
  ds_read_b64_tr_b16 v[62:63], v12 offset:13056
  s_waitcnt lgkmcnt(14)
  v_mfma_f32_32x32x16_bf16 v[100:115], v[76:79], v[24:27], v[100:115]
  ds_read_b64_tr_b16 v[64:65], v12 offset:12352
  ds_read_b64_tr_b16 v[66:67], v12 offset:13120
  s_waitcnt lgkmcnt(14)
  v_mfma_f32_32x32x16_bf16 v[116:131], v[24:27], v[80:83], v[116:131]
  ds_read_b64_tr_b16 v[68:69], v12 offset:12416
  ds_read_b64_tr_b16 v[70:71], v12 offset:13184
  s_waitcnt lgkmcnt(14)
  v_mfma_f32_32x32x16_bf16 v[84:99], v[48:51], v[28:31], v[84:99]
  ds_read_b64_tr_b16 v[72:73], v12 offset:15360
  ds_read_b64_tr_b16 v[74:75], v12 offset:16128
  s_waitcnt lgkmcnt(14)
  v_mfma_f32_32x32x16_bf16 v[100:115], v[52:55], v[28:31], v[100:115]
  ds_read_b64_tr_b16 v[76:77], v12 offset:15424
  ds_read_b64_tr_b16 v[78:79], v12 offset:16192
  s_waitcnt lgkmcnt(14)
  v_mfma_f32_32x32x16_bf16 v[116:131], v[28:31], v[56:59], v[116:131]
  ds_read_b64_tr_b16 v[80:81], v12 offset:15488
  ds_read_b64_tr_b16 v[82:83], v12 offset:16256
  s_waitcnt lgkmcnt(10)
  v_mfma_f32_32x32x16_bf16 v[84:99], v[60:63], v[32:35], v[84:99]
  ds_read_b64_tr_b16 v[48:49], v12 offset:18432
  ds_read_b64_tr_b16 v[50:51], v12 offset:19200
  s_waitcnt lgkmcnt(10)
  v_mfma_f32_32x32x16_bf16 v[100:115], v[64:67], v[32:35], v[100:115]
  ds_read_b64_tr_b16 v[52:53], v12 offset:18496
  ds_read_b64_tr_b16 v[54:55], v12 offset:19264
  s_waitcnt lgkmcnt(10)
  v_mfma_f32_32x32x16_bf16 v[116:131], v[32:35], v[68:71], v[116:131]
  ds_read_b64_tr_b16 v[56:57], v12 offset:18560
  ds_read_b64_tr_b16 v[58:59], v12 offset:19328
  s_waitcnt lgkmcnt(10)
  v_mfma_f32_32x32x16_bf16 v[84:99], v[72:75], v[36:39], v[84:99]
  ds_read_b64_tr_b16 v[60:61], v12 offset:21504
  ds_read_b64_tr_b16 v[62:63], v12 offset:22272
  s_waitcnt lgkmcnt(10)
  v_mfma_f32_32x32x16_bf16 v[100:115], v[76:79], v[36:39], v[100:115]
  ds_read_b64_tr_b16 v[64:65], v12 offset:21568
  ds_read_b64_tr_b16 v[66:67], v12 offset:22336
  s_waitcnt lgkmcnt(10)
  v_mfma_f32_32x32x16_bf16 v[116:131], v[36:39], v[80:83], v[116:131]
  ds_read_b64_tr_b16 v[68:69], v12 offset:21632
  ds_read_b64_tr_b16 v[70:71], v12 offset:22400
  s_waitcnt lgkmcnt(10)
  v_mfma_f32_32x32x16_bf16 v[84:99], v[48:51], v[40:43], v[84:99]
  s_waitcnt vmcnt(2)
  s_barrier
  ds_read_b128 v[16:19], v8 offset:32768
  ds_read_b128 v[20:23], v9 offset:32768
  ds_read_b128 v[24:27], v10 offset:32768
  ds_read_b128 v[28:31], v11 offset:32768
  ds_read_b64_tr_b16 v[72:73], v12 offset:24576
  ds_read_b64_tr_b16 v[74:75], v12 offset:25344
  s_waitcnt lgkmcnt(14)
  v_mfma_f32_32x32x16_bf16 v[100:115], v[52:55], v[40:43], v[100:115]
  ds_read_b64_tr_b16 v[76:77], v12 offset:24640
  ds_read_b64_tr_b16 v[78:79], v12 offset:25408
  s_waitcnt lgkmcnt(14)
  v_mfma_f32_32x32x16_bf16 v[116:131], v[40:43], v[56:59], v[116:131]
  ds_read_b64_tr_b16 v[80:81], v12 offset:24704
  ds_read_b64_tr_b16 v[82:83], v12 offset:25472
  s_waitcnt lgkmcnt(14)
  v_mfma_f32_32x32x16_bf16 v[84:99], v[60:63], v[44:47], v[84:99]
  ds_read_b64_tr_b16 v[48:49], v12 offset:27648
  ds_read_b64_tr_b16 v[50:51], v12 offset:28416
  s_waitcnt lgkmcnt(14)
  v_mfma_f32_32x32x16_bf16 v[100:115], v[64:67], v[44:47], v[100:115]
  ds_read_b64_tr_b16 v[52:53], v12 offset:27712
  ds_read_b64_tr_b16 v[54:55], v12 offset:28480
  s_waitcnt lgkmcnt(14)
  v_mfma_f32_32x32x16_bf16 v[116:131], v[44:47], v[68:71], v[116:131]
  ds_read_b64_tr_b16 v[56:57], v12 offset:27776
  ds_read_b64_tr_b16 v[58:59], v12 offset:28544
  s_waitcnt lgkmcnt(10)
  v_mfma_f32_32x32x16_bf16 v[84:99], v[72:75], v[16:19], v[84:99]
  ds_read_b64_tr_b16 v[60:61], v12 offset:30720
  ds_read_b64_tr_b16 v[62:63], v12 offset:31488
  s_waitcnt lgkmcnt(10)
  v_mfma_f32_32x32x16_bf16 v[100:115], v[76:79], v[16:19], v[100:115]
  ds_read_b64_tr_b16 v[64:65], v12 offset:30784
  ds_read_b64_tr_b16 v[66:67], v12 offset:31552
  s_waitcnt lgkmcnt(10)
  v_mfma_f32_32x32x16_bf16 v[116:131], v[16:19], v[80:83], v[116:131]
  ds_read_b64_tr_b16 v[68:69], v12 offset:30848
  ds_read_b64_tr_b16 v[70:71], v12 offset:31616
  s_waitcnt lgkmcnt(10)
  v_mfma_f32_32x32x16_bf16 v[84:99], v[48:51], v[20:23], v[84:99]
  ds_read_b64_tr_b16 v[72:73], v12 offset:33792
  ds_read_b64_tr_b16 v[74:75], v12 offset:34560
  s_waitcnt lgkmcnt(10)
  v_mfma_f32_32x32x16_bf16 v[100:115], v[52:55], v[20:23], v[100:115]
  ds_read_b64_tr_b16 v[76:77], v12 offset:33856
  ds_read_b64_tr_b16 v[78:79], v12 offset:34624
  s_waitcnt lgkmcnt(10)
  v_mfma_f32_32x32x16_bf16 v[116:131], v[20:23], v[56:59], v[116:131]
  ds_read_b64_tr_b16 v[80:81], v12 offset:33920
  ds_read_b64_tr_b16 v[82:83], v12 offset:34688
  s_waitcnt lgkmcnt(10)
  v_mfma_f32_32x32x16_bf16 v[84:99], v[60:63], v[24:27], v[84:99]
  s_barrier
  ds_read_b128 v[32:35], v8 offset:49152
  ds_read_b128 v[36:39], v9 offset:49152
  ds_read_b128 v[40:43], v10 offset:49152
  ds_read_b128 v[44:47], v11 offset:49152
  ds_read_b64_tr_b16 v[48:49], v12 offset:36864
  ds_read_b64_tr_b16 v[50:51], v12 offset:37632
  s_waitcnt lgkmcnt(14)
  v_mfma_f32_32x32x16_bf16 v[100:115], v[64:67], v[24:27], v[100:115]
  ds_read_b64_tr_b16 v[52:53], v12 offset:36928
  ds_read_b64_tr_b16 v[54:55], v12 offset:37696
  s_waitcnt lgkmcnt(14)
  v_mfma_f32_32x32x16_bf16 v[116:131], v[24:27], v[68:71], v[116:131]
  ds_read_b64_tr_b16 v[56:57], v12 offset:36992
  ds_read_b64_tr_b16 v[58:59], v12 offset:37760
  s_waitcnt lgkmcnt(14)
  v_mfma_f32_32x32x16_bf16 v[84:99], v[72:75], v[28:31], v[84:99]
  ds_read_b64_tr_b16 v[60:61], v12 offset:39936
  ds_read_b64_tr_b16 v[62:63], v12 offset:40704
  s_waitcnt lgkmcnt(14)
  v_mfma_f32_32x32x16_bf16 v[100:115], v[76:79], v[28:31], v[100:115]
  ds_read_b64_tr_b16 v[64:65], v12 offset:40000
  ds_read_b64_tr_b16 v[66:67], v12 offset:40768
  s_waitcnt lgkmcnt(14)
  v_mfma_f32_32x32x16_bf16 v[116:131], v[28:31], v[80:83], v[116:131]
  ds_read_b64_tr_b16 v[68:69], v12 offset:40064
  ds_read_b64_tr_b16 v[70:71], v12 offset:40832
  s_waitcnt lgkmcnt(10)
  v_mfma_f32_32x32x16_bf16 v[84:99], v[48:51], v[32:35], v[84:99]
  ds_read_b64_tr_b16 v[72:73], v12 offset:43008
  ds_read_b64_tr_b16 v[74:75], v12 offset:43776
  s_waitcnt lgkmcnt(10)
  v_mfma_f32_32x32x16_bf16 v[100:115], v[52:55], v[32:35], v[100:115]
  ds_read_b64_tr_b16 v[76:77], v12 offset:43072
  ds_read_b64_tr_b16 v[78:79], v12 offset:43840
  s_waitcnt lgkmcnt(10)
  v_mfma_f32_32x32x16_bf16 v[116:131], v[32:35], v[56:59], v[116:131]
  ds_read_b64_tr_b16 v[80:81], v12 offset:43136
  ds_read_b64_tr_b16 v[82:83], v12 offset:43904
  s_waitcnt lgkmcnt(10)
  v_mfma_f32_32x32x16_bf16 v[84:99], v[60:63], v[36:39], v[84:99]
  ds_read_b64_tr_b16 v[48:49], v12 offset:46080
  ds_read_b64_tr_b16 v[50:51], v12 offset:46848
  s_waitcnt lgkmcnt(10)
  v_mfma_f32_32x32x16_bf16 v[100:115], v[64:67], v[36:39], v[100:115]
  ds_read_b64_tr_b16 v[52:53], v12 offset:46144
  ds_read_b64_tr_b16 v[54:55], v12 offset:46912
  s_waitcnt lgkmcnt(10)
  v_mfma_f32_32x32x16_bf16 v[116:131], v[36:39], v[68:71], v[116:131]
  ds_read_b64_tr_b16 v[56:57], v12 offset:46208
  ds_read_b64_tr_b16 v[58:59], v12 offset:46976
  s_waitcnt lgkmcnt(10)
  v_mfma_f32_32x32x16_bf16 v[84:99], v[72:75], v[40:43], v[84:99]
  s_barrier
  v_add_u32 v8, 0x10000, v8
  v_add_u32 v9, 0x10000, v9
  v_add_u32 v10, 0x10000, v10
  v_add_u32 v11, 0x10000, v11
  ds_read_b128 v[16:19], v8 offset:0
  ds_read_b128 v[20:23], v9 offset:0
  ds_read_b128 v[24:27], v10 offset:0
  ds_read_b128 v[28:31], v11 offset:0
  ds_read_b64_tr_b16 v[60:61], v189 offset:0
  ds_read_b64_tr_b16 v[62:63], v189 offset:768
  s_waitcnt lgkmcnt(14)
  v_mfma_f32_32x32x16_bf16 v[100:115], v[76:79], v[40:43], v[100:115]
  ds_read_b64_tr_b16 v[64:65], v189 offset:64
  ds_read_b64_tr_b16 v[66:67], v189 offset:832
  s_waitcnt lgkmcnt(14)
  v_mfma_f32_32x32x16_bf16 v[116:131], v[40:43], v[80:83], v[116:131]
  ds_read_b64_tr_b16 v[68:69], v189 offset:128
  ds_read_b64_tr_b16 v[70:71], v189 offset:896
  s_waitcnt lgkmcnt(14)
  v_mfma_f32_32x32x16_bf16 v[84:99], v[48:51], v[44:47], v[84:99]
  ds_read_b64_tr_b16 v[72:73], v189 offset:3072
  ds_read_b64_tr_b16 v[74:75], v189 offset:3840
  s_waitcnt lgkmcnt(14)
  v_mfma_f32_32x32x16_bf16 v[100:115], v[52:55], v[44:47], v[100:115]
  ds_read_b64_tr_b16 v[76:77], v189 offset:3136
  ds_read_b64_tr_b16 v[78:79], v189 offset:3904
  s_waitcnt lgkmcnt(14)
  v_mfma_f32_32x32x16_bf16 v[116:131], v[44:47], v[56:59], v[116:131]
  ds_read_b64_tr_b16 v[80:81], v189 offset:3200
  ds_read_b64_tr_b16 v[82:83], v189 offset:3968
  s_waitcnt lgkmcnt(10)
  v_mfma_f32_32x32x16_bf16 v[84:99], v[60:63], v[16:19], v[84:99]
  ds_read_b64_tr_b16 v[48:49], v189 offset:6144
  ds_read_b64_tr_b16 v[50:51], v189 offset:6912
  s_waitcnt lgkmcnt(10)
  v_mfma_f32_32x32x16_bf16 v[100:115], v[64:67], v[16:19], v[100:115]
  ds_read_b64_tr_b16 v[52:53], v189 offset:6208
  ds_read_b64_tr_b16 v[54:55], v189 offset:6976
  s_waitcnt lgkmcnt(10)
  v_mfma_f32_32x32x16_bf16 v[116:131], v[16:19], v[68:71], v[116:131]
  ds_read_b64_tr_b16 v[56:57], v189 offset:6272
  ds_read_b64_tr_b16 v[58:59], v189 offset:7040
  s_waitcnt lgkmcnt(10)
  v_mfma_f32_32x32x16_bf16 v[84:99], v[72:75], v[20:23], v[84:99]
  ds_read_b64_tr_b16 v[60:61], v189 offset:9216
  ds_read_b64_tr_b16 v[62:63], v189 offset:9984
  s_waitcnt lgkmcnt(10)
  v_mfma_f32_32x32x16_bf16 v[100:115], v[76:79], v[20:23], v[100:115]
  ds_read_b64_tr_b16 v[64:65], v189 offset:9280
  ds_read_b64_tr_b16 v[66:67], v189 offset:10048
  s_waitcnt lgkmcnt(10)
  v_mfma_f32_32x32x16_bf16 v[116:131], v[20:23], v[80:83], v[116:131]
  ds_read_b64_tr_b16 v[68:69], v189 offset:9344
  ds_read_b64_tr_b16 v[70:71], v189 offset:10112
  s_waitcnt lgkmcnt(10)
  v_mfma_f32_32x32x16_bf16 v[84:99], v[48:51], v[24:27], v[84:99]
  s_barrier
  v_subrev_u32 v8, 0x10000, v8
  v_subrev_u32 v9, 0x10000, v9
  v_subrev_u32 v10, 0x10000, v10
  v_subrev_u32 v11, 0x10000, v11
  ds_read_b128 v[32:35], v8 offset:0
  ds_read_b128 v[36:39], v9 offset:0
  ds_read_b128 v[40:43], v10 offset:0
  ds_read_b128 v[44:47], v11 offset:0
  ds_read_b64_tr_b16 v[72:73], v189 offset:12288
  ds_read_b64_tr_b16 v[74:75], v189 offset:13056
  s_waitcnt lgkmcnt(14)
  v_mfma_f32_32x32x16_bf16 v[100:115], v[52:55], v[24:27], v[100:115]
  ds_read_b64_tr_b16 v[76:77], v189 offset:12352
  ds_read_b64_tr_b16 v[78:79], v189 offset:13120
  s_waitcnt lgkmcnt(14)
  v_mfma_f32_32x32x16_bf16 v[116:131], v[24:27], v[56:59], v[116:131]
  ds_read_b64_tr_b16 v[80:81], v189 offset:12416
  ds_read_b64_tr_b16 v[82:83], v189 offset:13184
  s_waitcnt lgkmcnt(14)
  v_mfma_f32_32x32x16_bf16 v[84:99], v[60:63], v[28:31], v[84:99]
  ds_read_b64_tr_b16 v[48:49], v189 offset:15360
  ds_read_b64_tr_b16 v[50:51], v189 offset:16128
  s_waitcnt lgkmcnt(14)
  v_mfma_f32_32x32x16_bf16 v[100:115], v[64:67], v[28:31], v[100:115]
  ds_read_b64_tr_b16 v[52:53], v189 offset:15424
  ds_read_b64_tr_b16 v[54:55], v189 offset:16192
  s_waitcnt lgkmcnt(14)
  v_mfma_f32_32x32x16_bf16 v[116:131], v[28:31], v[68:71], v[116:131]
  ds_read_b64_tr_b16 v[56:57], v189 offset:15488
  ds_read_b64_tr_b16 v[58:59], v189 offset:16256
  s_waitcnt lgkmcnt(10)
  v_mfma_f32_32x32x16_bf16 v[84:99], v[72:75], v[32:35], v[84:99]
  ds_read_b64_tr_b16 v[60:61], v189 offset:18432
  ds_read_b64_tr_b16 v[62:63], v189 offset:19200
  s_waitcnt lgkmcnt(10)
  v_mfma_f32_32x32x16_bf16 v[100:115], v[76:79], v[32:35], v[100:115]
  ds_read_b64_tr_b16 v[64:65], v189 offset:18496
  ds_read_b64_tr_b16 v[66:67], v189 offset:19264
  s_waitcnt lgkmcnt(10)
  v_mfma_f32_32x32x16_bf16 v[116:131], v[32:35], v[80:83], v[116:131]
  ds_read_b64_tr_b16 v[68:69], v189 offset:18560
  ds_read_b64_tr_b16 v[70:71], v189 offset:19328
  s_waitcnt lgkmcnt(10)
  v_mfma_f32_32x32x16_bf16 v[84:99], v[48:51], v[36:39], v[84:99]
  ds_read_b64_tr_b16 v[72:73], v189 offset:21504
  ds_read_b64_tr_b16 v[74:75], v189 offset:22272
  s_waitcnt lgkmcnt(10)
  v_mfma_f32_32x32x16_bf16 v[100:115], v[52:55], v[36:39], v[100:115]
  ds_read_b64_tr_b16 v[76:77], v189 offset:21568
  ds_read_b64_tr_b16 v[78:79], v189 offset:22336
  s_waitcnt lgkmcnt(10)
  v_mfma_f32_32x32x16_bf16 v[116:131], v[36:39], v[56:59], v[116:131]
  ds_read_b64_tr_b16 v[80:81], v189 offset:21632
  ds_read_b64_tr_b16 v[82:83], v189 offset:22400
  s_waitcnt lgkmcnt(10)
  v_mfma_f32_32x32x16_bf16 v[84:99], v[60:63], v[40:43], v[84:99]
  s_barrier
  ds_read_b128 v[16:19], v8 offset:16384
  ds_read_b128 v[20:23], v9 offset:16384
  ds_read_b128 v[24:27], v10 offset:16384
  ds_read_b128 v[28:31], v11 offset:16384
  ds_read_b64_tr_b16 v[48:49], v12 offset:0
  ds_read_b64_tr_b16 v[50:51], v12 offset:768
  s_waitcnt lgkmcnt(14)
  v_mfma_f32_32x32x16_bf16 v[100:115], v[64:67], v[40:43], v[100:115]
  ds_read_b64_tr_b16 v[52:53], v12 offset:64
  ds_read_b64_tr_b16 v[54:55], v12 offset:832
  s_waitcnt lgkmcnt(14)
  v_mfma_f32_32x32x16_bf16 v[116:131], v[40:43], v[68:71], v[116:131]
  ds_read_b64_tr_b16 v[56:57], v12 offset:128
  ds_read_b64_tr_b16 v[58:59], v12 offset:896
  s_waitcnt lgkmcnt(14)
  v_mfma_f32_32x32x16_bf16 v[84:99], v[72:75], v[44:47], v[84:99]
  ds_read_b64_tr_b16 v[60:61], v12 offset:3072
  ds_read_b64_tr_b16 v[62:63], v12 offset:3840
  s_waitcnt lgkmcnt(14)
  v_mfma_f32_32x32x16_bf16 v[100:115], v[76:79], v[44:47], v[100:115]
  ds_read_b64_tr_b16 v[64:65], v12 offset:3136
  ds_read_b64_tr_b16 v[66:67], v12 offset:3904
  s_waitcnt lgkmcnt(14)
  v_mfma_f32_32x32x16_bf16 v[116:131], v[44:47], v[80:83], v[116:131]
  ds_read_b64_tr_b16 v[68:69], v12 offset:3200
  ds_read_b64_tr_b16 v[70:71], v12 offset:3968
  s_waitcnt lgkmcnt(10)
  v_mfma_f32_32x32x16_bf16 v[84:99], v[48:51], v[16:19], v[84:99]
  ds_read_b64_tr_b16 v[72:73], v12 offset:6144
  ds_read_b64_tr_b16 v[74:75], v12 offset:6912
  s_waitcnt lgkmcnt(10)
  v_mfma_f32_32x32x16_bf16 v[100:115], v[52:55], v[16:19], v[100:115]
  ds_read_b64_tr_b16 v[76:77], v12 offset:6208
  ds_read_b64_tr_b16 v[78:79], v12 offset:6976
  s_waitcnt lgkmcnt(10)
  v_mfma_f32_32x32x16_bf16 v[116:131], v[16:19], v[56:59], v[116:131]
  ds_read_b64_tr_b16 v[80:81], v12 offset:6272
  ds_read_b64_tr_b16 v[82:83], v12 offset:7040
  s_waitcnt lgkmcnt(10)
  v_mfma_f32_32x32x16_bf16 v[84:99], v[60:63], v[20:23], v[84:99]
  ds_read_b64_tr_b16 v[48:49], v12 offset:9216
  ds_read_b64_tr_b16 v[50:51], v12 offset:9984
  s_waitcnt lgkmcnt(10)
  v_mfma_f32_32x32x16_bf16 v[100:115], v[64:67], v[20:23], v[100:115]
  ds_read_b64_tr_b16 v[52:53], v12 offset:9280
  ds_read_b64_tr_b16 v[54:55], v12 offset:10048
  s_waitcnt lgkmcnt(10)
  v_mfma_f32_32x32x16_bf16 v[116:131], v[20:23], v[68:71], v[116:131]
  ds_read_b64_tr_b16 v[56:57], v12 offset:9344
  ds_read_b64_tr_b16 v[58:59], v12 offset:10112
  s_waitcnt lgkmcnt(10)
  v_mfma_f32_32x32x16_bf16 v[84:99], v[72:75], v[24:27], v[84:99]
  s_barrier
  ds_read_b128 v[32:35], v8 offset:32768
  ds_read_b128 v[36:39], v9 offset:32768
  ds_read_b128 v[40:43], v10 offset:32768
  ds_read_b128 v[44:47], v11 offset:32768
  ds_read_b64_tr_b16 v[60:61], v12 offset:12288
  ds_read_b64_tr_b16 v[62:63], v12 offset:13056
  s_waitcnt lgkmcnt(14)
  v_mfma_f32_32x32x16_bf16 v[100:115], v[76:79], v[24:27], v[100:115]
  ds_read_b64_tr_b16 v[64:65], v12 offset:15360
  ds_read_b64_tr_b16 v[66:67], v12 offset:16128
  s_waitcnt lgkmcnt(14)
  v_mfma_f32_32x32x16_bf16 v[116:131], v[24:27], v[80:83], v[116:131]
  ds_read_b64_tr_b16 v[68:69], v12 offset:18432
  ds_read_b64_tr_b16 v[70:71], v12 offset:19200
  s_waitcnt lgkmcnt(14)
  v_mfma_f32_32x32x16_bf16 v[84:99], v[48:51], v[28:31], v[84:99]
  ds_read_b64_tr_b16 v[72:73], v12 offset:21504
  ds_read_b64_tr_b16 v[74:75], v12 offset:22272
  s_waitcnt lgkmcnt(14)
  v_mfma_f32_32x32x16_bf16 v[100:115], v[52:55], v[28:31], v[100:115]
  ds_read_b64_tr_b16 v[76:77], v12 offset:12352
  ds_read_b64_tr_b16 v[78:79], v12 offset:13120
  s_waitcnt lgkmcnt(14)
  v_mfma_f32_32x32x16_bf16 v[116:131], v[28:31], v[56:59], v[116:131]
  ds_read_b64_tr_b16 v[80:81], v12 offset:15424
  ds_read_b64_tr_b16 v[82:83], v12 offset:16192
  s_waitcnt lgkmcnt(10)
  v_mfma_f32_32x32x16_bf16 v[84:99], v[60:63], v[32:35], v[84:99]
  ds_read_b64_tr_b16 v[48:49], v12 offset:18496
  ds_read_b64_tr_b16 v[50:51], v12 offset:19264
  s_waitcnt lgkmcnt(10)
  v_mfma_f32_32x32x16_bf16 v[84:99], v[64:67], v[36:39], v[84:99]
  ds_read_b64_tr_b16 v[52:53], v12 offset:21568
  ds_read_b64_tr_b16 v[54:55], v12 offset:22336
  s_barrier
  ds_read_b64 v[132:133], v15 offset:0
  ds_read_b64 v[134:135], v15 offset:256
  ds_read_b64 v[136:137], v15 offset:512
  ds_read2_b32 v[138:139], v188 offset0:128 offset1:128
  ds_read2_b32 v[160:161], v188 offset0:0 offset1:0
  ds_read_b128 v[144:147], v4 offset:0
  ds_read_b128 v[148:151], v4 offset:32
  ds_read_b128 v[152:155], v4 offset:64
  ds_read_b128 v[156:159], v4 offset:96
  s_waitcnt lgkmcnt(15)
  v_mfma_f32_32x32x16_bf16 v[84:99], v[68:71], v[40:43], v[84:99]
  ds_read_b64_tr_b16 v[56:57], v12 offset:12416
  ds_read_b64_tr_b16 v[58:59], v12 offset:13184
  v_mfma_f32_32x32x16_bf16 v[84:99], v[72:75], v[44:47], v[84:99]
  ds_read_b64_tr_b16 v[60:61], v12 offset:15488
  ds_read_b64_tr_b16 v[62:63], v12 offset:16256
  s_waitcnt lgkmcnt(8)
  v_mul_f32 v162, 0x3eb8aa3b, v160
  v_mul_f32 v163, 0x3eb8aa3b, v160
  v_mfma_f32_32x32x16_bf16 v[84:99], v[132:135], v[138:141], v[84:99]
  v_mfma_f32_32x32x16_bf16 v[100:115], v[76:79], v[32:35], v[100:115]
  ds_read_b64_tr_b16 v[64:65], v12 offset:18560
  ds_read_b64_tr_b16 v[66:67], v12 offset:19328
  v_mfma_f32_32x32x16_bf16 v[100:115], v[80:83], v[36:39], v[100:115]
  ds_read_b64_tr_b16 v[68:69], v12 offset:21632
  ds_read_b64_tr_b16 v[70:71], v12 offset:22400
  s_nop 5
  v_mul_f32 v84, v84, v162
  v_mul_f32 v85, v85, v162
  v_mul_f32 v86, v86, v162
  v_mul_f32 v87, v87, v162
  v_mul_f32 v88, v88, v162
  v_mul_f32 v89, v89, v162
  v_mul_f32 v90, v90, v162
  v_mul_f32 v91, v91, v162
  v_cvt_pk_bf16_f32 v164, v84, v85
  v_mfma_f32_32x32x16_bf16 v[100:115], v[48:51], v[40:43], v[100:115]
  v_cvt_pk_bf16_f32 v165, v86, v87
  v_cvt_pk_bf16_f32 v166, v88, v89
  v_cvt_pk_bf16_f32 v167, v90, v91
  buffer_store_dwordx4 v[164:167], v142, s[20:23], 0 offen sc1
  v_mul_f32 v92, v92, v162
  v_mul_f32 v93, v93, v162
  v_mul_f32 v94, v94, v162
  v_mul_f32 v95, v95, v162
  v_mul_f32 v96, v96, v162
  v_mfma_f32_32x32x16_bf16 v[100:115], v[52:55], v[44:47], v[100:115]
  v_mul_f32 v97, v97, v162
  v_mul_f32 v98, v98, v162
  v_mul_f32 v99, v99, v162
  v_cvt_pk_bf16_f32 v168, v92, v93
  v_cvt_pk_bf16_f32 v169, v94, v95
  v_cvt_pk_bf16_f32 v170, v96, v97
  v_cvt_pk_bf16_f32 v171, v98, v99
  buffer_store_dwordx4 v[168:171], v142, s[20:23], s24 offen sc1
  v_mfma_f32_32x32x16_bf16 v[100:115], v[134:137], v[138:141], v[100:115]
  s_waitcnt lgkmcnt(6)
  v_mfma_f32_32x32x16_bf16 v[116:131], v[32:35], v[56:59], v[116:131]
  s_waitcnt lgkmcnt(4)
  v_mfma_f32_32x32x16_bf16 v[116:131], v[36:39], v[60:63], v[116:131]
  s_nop 7
  v_mul_f32 v100, v100, v160
  v_mul_f32 v101, v101, v160
  v_mul_f32 v102, v102, v160
  v_mul_f32 v103, v103, v160
  v_mul_f32 v104, v104, v160
  v_mul_f32 v105, v105, v160
  v_mul_f32 v106, v106, v160
  v_mul_f32 v107, v107, v160
  v_cvt_pk_bf16_f32 v172, v100, v101
  s_waitcnt lgkmcnt(2)
  v_mfma_f32_32x32x16_bf16 v[116:131], v[40:43], v[64:67], v[116:131]
  v_cvt_pk_bf16_f32 v173, v102, v103
  v_cvt_pk_bf16_f32 v174, v104, v105
  v_cvt_pk_bf16_f32 v175, v106, v107
  buffer_store_dwordx4 v[172:175], v142, s[20:23], s26 offen sc1
  v_mul_f32 v108, v108, v160
  v_mul_f32 v109, v109, v160
  v_mul_f32 v110, v110, v160
  v_mul_f32 v111, v111, v160
  v_mul_f32 v112, v112, v160
  s_waitcnt lgkmcnt(0)
  v_mfma_f32_32x32x16_bf16 v[116:131], v[44:47], v[68:71], v[116:131]
  v_mul_f32 v113, v113, v160
  v_mul_f32 v114, v114, v160
  v_mul_f32 v115, v115, v160
  v_cvt_pk_bf16_f32 v176, v108, v109
  v_cvt_pk_bf16_f32 v177, v110, v111
  v_cvt_pk_bf16_f32 v178, v112, v113
  v_cvt_pk_bf16_f32 v179, v114, v115
  buffer_store_dwordx4 v[176:179], v142, s[20:23], s27 offen sc1
  v_mfma_f32_32x32x16_bf16 v[116:131], v[138:141], v[136:139], v[116:131]
  s_nop 11
  v_pk_mul_f32 v[116:117], v[116:117], v[144:145]
  v_pk_mul_f32 v[118:119], v[118:119], v[146:147]
  v_pk_mul_f32 v[120:121], v[120:121], v[148:149]
  v_pk_mul_f32 v[122:123], v[122:123], v[150:151]
  v_cvt_pk_bf16_f32 v180, v116, v117
  v_cvt_pk_bf16_f32 v181, v118, v119
  v_cvt_pk_bf16_f32 v182, v120, v121
  v_cvt_pk_bf16_f32 v183, v122, v123
  s_nop 0
  v_permlane32_swap_b32 v180, v182
  v_permlane32_swap_b32 v181, v183
  buffer_store_dwordx4 v[180:183], v143, s[20:23], s9 offen offset:0 sc1
  v_pk_mul_f32 v[124:125], v[124:125], v[152:153]
  v_pk_mul_f32 v[126:127], v[126:127], v[154:155]
  v_pk_mul_f32 v[128:129], v[128:129], v[156:157]
  v_pk_mul_f32 v[130:131], v[130:131], v[158:159]
  v_cvt_pk_bf16_f32 v184, v124, v125
  v_cvt_pk_bf16_f32 v185, v126, v127
  v_cvt_pk_bf16_f32 v186, v128, v129
  v_cvt_pk_bf16_f32 v187, v130, v131
  s_nop 0
  v_permlane32_swap_b32 v184, v186
  v_permlane32_swap_b32 v185, v187
  buffer_store_dwordx4 v[184:187], v143, s[20:23], s9 offen offset:512 sc1
  v_add_u32 v251, 1, v251
  s_setprio 0
  s_waitcnt vmcnt(0)
  s_mov_b64 exec, 1
  buffer_store_dword v251, v250, s[20:23], 0 offen sc1
  s_mov_b64 exec, -1
  s_branch k6_kernel_fin4
k6_kernel_helper3:
  v_lshrrev_b32 v2, 3, v1
  v_lshrrev_b32 v3, 4, v1
  v_xor_b32 v3, v3, v1
  v_and_b32 v3, 7, v3
  v_lshlrev_b32 v3, 4, v3
  v_lshl_or_b32 v48, v2, 10, v3
  v_xor_b32 v49, 64, v48
  v_add_u32 v49, 0x1c00, v49
  v_add_u32 v50, 0x3800, v48
  v_xor_b32 v51, 64, v48
  v_add_u32 v51, 0x5400, v51
  s_lshl_b32 s24, s11, 15
  s_waitcnt lgkmcnt(0)
  s_add_u32 m0, s25, 0
  s_add_u32 s8, s28, 0
  s_and_b32 s8, s8, 7
  s_lshl_b32 s8, s8, 7
  s_add_u32 s8, s8, s24
  buffer_load_dwordx4 v48, s[12:15], s8 offen offset:0 lds
  buffer_load_dwordx4 v49, s[12:15], s8 offen offset:1024 lds
  buffer_load_dwordx4 v50, s[12:15], s8 offen offset:2048 lds
  buffer_load_dwordx4 v51, s[12:15], s8 offen offset:3072 lds
  s_add_u32 m0, s25, 0x4000
  s_add_u32 s8, s28, 1
  s_and_b32 s8, s8, 7
  s_lshl_b32 s8, s8, 7
  s_add_u32 s8, s8, s24
  buffer_load_dwordx4 v48, s[12:15], s8 offen offset:0 lds
  buffer_load_dwordx4 v49, s[12:15], s8 offen offset:1024 lds
  buffer_load_dwordx4 v50, s[12:15], s8 offen offset:2048 lds
  buffer_load_dwordx4 v51, s[12:15], s8 offen offset:3072 lds
  s_lshl_b32 s9, s10, 6
  v_add_u32 v2, 0, v1
  v_mul_u32_u24 v3, 0xab, v2
  v_lshrrev_b32 v3, 11, v3
  v_mul_u32_u24 v4, 12, v3
  v_sub_u32 v2, v2, v4
  v_mul_u32_u24 v3, 0xc00, v3
  v_lshrrev_b32 v4, 2, v2
  v_lshl_add_u32 v3, v4, 10, v3
  v_and_b32 v2, 3, v2
  v_lshl_add_u32 v3, v2, 4, v3
  v_add_u32 v5, s9, v3
  v_add_u32 v2, 64, v1
  v_mul_u32_u24 v3, 0xab, v2
  v_lshrrev_b32 v3, 11, v3
  v_mul_u32_u24 v4, 12, v3
  v_sub_u32 v2, v2, v4
  v_mul_u32_u24 v3, 0xc00, v3
  v_lshrrev_b32 v4, 2, v2
  v_lshl_add_u32 v3, v4, 10, v3
  v_and_b32 v2, 3, v2
  v_lshl_add_u32 v3, v2, 4, v3
  v_add_u32 v6, s9, v3
  v_subrev_u32 v6, 0x400, v6
  v_add_u32 v2, 0x80, v1
  v_mul_u32_u24 v3, 0xab, v2
  v_lshrrev_b32 v3, 11, v3
  v_mul_u32_u24 v4, 12, v3
  v_sub_u32 v2, v2, v4
  v_mul_u32_u24 v3, 0xc00, v3
  v_lshrrev_b32 v4, 2, v2
  v_lshl_add_u32 v3, v4, 10, v3
  v_and_b32 v2, 3, v2
  v_lshl_add_u32 v3, v2, 4, v3
  v_add_u32 v7, s9, v3
  v_subrev_u32 v7, 0x800, v7
  s_add_u32 m0, s25, 0x8000
  s_add_u32 s8, s28, 2
  s_and_b32 s8, s8, 7
  s_lshl_b32 s8, s8, 7
  s_add_u32 s8, s8, s24
  buffer_load_dwordx4 v48, s[12:15], s8 offen offset:0 lds
  buffer_load_dwordx4 v49, s[12:15], s8 offen offset:1024 lds
  buffer_load_dwordx4 v50, s[12:15], s8 offen offset:2048 lds
  buffer_load_dwordx4 v51, s[12:15], s8 offen offset:3072 lds
  s_add_u32 m0, s25, 0xc000
  s_add_u32 s8, s28, 3
  s_and_b32 s8, s8, 7
  s_lshl_b32 s8, s8, 7
  s_add_u32 s8, s8, s24
  buffer_load_dwordx4 v48, s[12:15], s8 offen offset:0 lds
  buffer_load_dwordx4 v49, s[12:15], s8 offen offset:1024 lds
  buffer_load_dwordx4 v50, s[12:15], s8 offen offset:2048 lds
  buffer_load_dwordx4 v51, s[12:15], s8 offen offset:3072 lds
  s_add_u32 m0, s27, 0x9000
  s_add_u32 s8, s28, 3
  s_and_b32 s8, s8, 7
  s_mul_i32 s8, s8, 0x30000
  s_add_u32 s8, s8, s26
  buffer_load_dwordx4 v5, s[16:19], s8 offen offset:0 lds
  buffer_load_dwordx4 v6, s[16:19], s8 offen offset:1024 lds
  buffer_load_dwordx4 v7, s[16:19], s8 offen offset:2048 lds
  v_and_b32 v13, 31, v1
  v_lshrrev_b32 v14, 5, v1
  v_bfe_u32 v2, v1, 1, 3
  v_xor_b32 v2, v2, v14
  v_lshlrev_b32 v2, 4, v2
  v_lshl_or_b32 v2, v13, 7, v2
  v_add_u32 v8, s25, v2
  v_xor_b32 v9, 32, v8
  v_xor_b32 v10, 64, v8
  v_xor_b32 v11, 0x60, v8
  v_bfe_u32 v2, v1, 2, 2
  v_lshl_add_u32 v2, v14, 3, v2
  v_mul_u32_u24 v2, 0xc0, v2
  v_bfe_u32 v3, v1, 4, 1
  v_lshl_add_u32 v2, v3, 5, v2
  v_and_b32 v4, 3, v1
  v_lshl_add_u32 v12, v4, 3, v2
  v_bfe_u32 v2, v1, 2, 1
  v_cmp_eq_u32 vcc, v2, v3
  v_mov_b32 v4, 0x3f803f80
  s_nop 0
  v_cndmask_b32 v52, 0, v4, vcc
  v_mov_b32 v53, v52
  v_mov_b32 v54, v52
  v_mov_b32 v55, v52
  s_min_u32 s8, s7, 2
  s_lshl_b32 s8, s8, 6
  v_add_u32 v12, s8, v12
  v_mov_b32 v92, 0
  v_mov_b32 v100, 0
  v_mov_b32 v93, 0
  v_mov_b32 v101, 0
  v_mov_b32 v94, 0
  v_mov_b32 v102, 0
  v_mov_b32 v95, 0
  v_mov_b32 v103, 0
  v_mov_b32 v96, 0
  v_mov_b32 v104, 0
  v_mov_b32 v97, 0
  v_mov_b32 v105, 0
  v_mov_b32 v98, 0
  v_mov_b32 v106, 0
  v_mov_b32 v99, 0
  v_mov_b32 v107, 0
  s_waitcnt vmcnt(15)
  ds_read_b128 v[16:19], v8 offset:0
  ds_read_b128 v[20:23], v9 offset:0
  ds_read_b128 v[24:27], v10 offset:0
  ds_read_b128 v[28:31], v11 offset:0
  s_barrier
  ds_read_b64_tr_b16 v[60:61], v12 offset:0
  ds_read_b64_tr_b16 v[62:63], v12 offset:768
  ds_read_b64_tr_b16 v[64:65], v12 offset:3072
  ds_read_b64_tr_b16 v[66:67], v12 offset:3840
  ds_read_b64_tr_b16 v[68:69], v12 offset:6144
  ds_read_b64_tr_b16 v[70:71], v12 offset:6912
  ds_read_b64_tr_b16 v[72:73], v12 offset:9216
  ds_read_b64_tr_b16 v[74:75], v12 offset:9984
  s_add_u32 m0, s25, 0x10000
  s_add_u32 s8, s28, 4
  s_and_b32 s8, s8, 7
  s_lshl_b32 s8, s8, 7
  s_add_u32 s8, s8, s24
  buffer_load_dwordx4 v48, s[12:15], s8 offen offset:0 lds
  buffer_load_dwordx4 v49, s[12:15], s8 offen offset:1024 lds
  buffer_load_dwordx4 v50, s[12:15], s8 offen offset:2048 lds
  buffer_load_dwordx4 v51, s[12:15], s8 offen offset:3072 lds
  s_add_u32 m0, s27, 0xc000
  s_add_u32 s8, s28, 4
  s_and_b32 s8, s8, 7
  s_mul_i32 s8, s8, 0x30000
  s_add_u32 s8, s8, s26
  buffer_load_dwordx4 v5, s[16:19], s8 offen offset:0 lds
  buffer_load_dwordx4 v6, s[16:19], s8 offen offset:1024 lds
  buffer_load_dwordx4 v7, s[16:19], s8 offen offset:2048 lds
  s_add_u32 m0, s27, 0xf000
  s_add_u32 s8, s28, 5
  s_and_b32 s8, s8, 7
  s_mul_i32 s8, s8, 0x30000
  s_add_u32 s8, s8, s26
  buffer_load_dwordx4 v5, s[16:19], s8 offen offset:0 lds
  buffer_load_dwordx4 v6, s[16:19], s8 offen offset:1024 lds
  buffer_load_dwordx4 v7, s[16:19], s8 offen offset:2048 lds
  s_waitcnt lgkmcnt(11)
  v_lshlrev_b32 v108, 16, v16
  v_and_b32 v109, 0xffff0000, v16
  v_lshlrev_b32 v110, 16, v17
  v_and_b32 v111, 0xffff0000, v17
  v_lshlrev_b32 v112, 16, v18
  v_and_b32 v113, 0xffff0000, v18
  v_lshlrev_b32 v114, 16, v19
  v_and_b32 v115, 0xffff0000, v19
  v_fmac_f32 v92, v108, v108
  v_fmac_f32 v93, v109, v109
  v_fmac_f32 v94, v110, v110
  v_fmac_f32 v95, v111, v111
  v_fmac_f32 v96, v112, v112
  v_fmac_f32 v97, v113, v113
  v_fmac_f32 v98, v114, v114
  v_fmac_f32 v99, v115, v115
  v_mfma_f32_16x16x32_bf16 v[100:103], v[52:55], v[16:19], v[100:103]
  s_waitcnt lgkmcnt(10)
  v_lshlrev_b32 v108, 16, v20
  v_and_b32 v109, 0xffff0000, v20
  v_lshlrev_b32 v110, 16, v21
  v_and_b32 v111, 0xffff0000, v21
  v_lshlrev_b32 v112, 16, v22
  v_and_b32 v113, 0xffff0000, v22
  v_lshlrev_b32 v114, 16, v23
  v_and_b32 v115, 0xffff0000, v23
  v_fmac_f32 v92, v108, v108
  v_fmac_f32 v93, v109, v109
  v_fmac_f32 v94, v110, v110
  v_fmac_f32 v95, v111, v111
  v_fmac_f32 v96, v112, v112
  v_fmac_f32 v97, v113, v113
  v_fmac_f32 v98, v114, v114
  v_fmac_f32 v99, v115, v115
  v_mfma_f32_16x16x32_bf16 v[100:103], v[52:55], v[20:23], v[100:103]
  s_waitcnt vmcnt(21)
  ds_read_b128 v[32:35], v8 offset:16384
  ds_read_b128 v[36:39], v9 offset:16384
  ds_read_b128 v[40:43], v10 offset:16384
  ds_read_b128 v[44:47], v11 offset:16384
  s_waitcnt lgkmcnt(13)
  v_lshlrev_b32 v108, 16, v24
  v_and_b32 v109, 0xffff0000, v24
  v_lshlrev_b32 v110, 16, v25
  v_and_b32 v111, 0xffff0000, v25
  v_lshlrev_b32 v112, 16, v26
  v_and_b32 v113, 0xffff0000, v26
  v_lshlrev_b32 v114, 16, v27
  v_and_b32 v115, 0xffff0000, v27
  v_fmac_f32 v92, v108, v108
  v_fmac_f32 v93, v109, v109
  v_fmac_f32 v94, v110, v110
  v_fmac_f32 v95, v111, v111
  v_fmac_f32 v96, v112, v112
  v_fmac_f32 v97, v113, v113
  v_fmac_f32 v98, v114, v114
  v_fmac_f32 v99, v115, v115
  v_mfma_f32_16x16x32_bf16 v[100:103], v[52:55], v[24:27], v[100:103]
  s_waitcnt lgkmcnt(12)
  v_lshlrev_b32 v108, 16, v28
  v_and_b32 v109, 0xffff0000, v28
  v_lshlrev_b32 v110, 16, v29
  v_and_b32 v111, 0xffff0000, v29
  v_lshlrev_b32 v112, 16, v30
  v_and_b32 v113, 0xffff0000, v30
  v_lshlrev_b32 v114, 16, v31
  v_and_b32 v115, 0xffff0000, v31
  v_fmac_f32 v92, v108, v108
  v_fmac_f32 v93, v109, v109
  v_fmac_f32 v94, v110, v110
  v_fmac_f32 v95, v111, v111
  v_fmac_f32 v96, v112, v112
  v_fmac_f32 v97, v113, v113
  v_fmac_f32 v98, v114, v114
  v_fmac_f32 v99, v115, v115
  v_mfma_f32_16x16x32_bf16 v[100:103], v[52:55], v[28:31], v[100:103]
  s_barrier
  ds_read_b64_tr_b16 v[76:77], v12 offset:12288
  ds_read_b64_tr_b16 v[78:79], v12 offset:13056
  ds_read_b64_tr_b16 v[80:81], v12 offset:15360
  ds_read_b64_tr_b16 v[82:83], v12 offset:16128
  ds_read_b64_tr_b16 v[84:85], v12 offset:18432
  ds_read_b64_tr_b16 v[86:87], v12 offset:19200
  ds_read_b64_tr_b16 v[88:89], v12 offset:21504
  ds_read_b64_tr_b16 v[90:91], v12 offset:22272
  s_add_u32 m0, s25, 0
  s_add_u32 s8, s28, 5
  s_and_b32 s8, s8, 7
  s_lshl_b32 s8, s8, 7
  s_add_u32 s8, s8, s24
  buffer_load_dwordx4 v48, s[12:15], s8 offen offset:0 lds
  buffer_load_dwordx4 v49, s[12:15], s8 offen offset:1024 lds
  buffer_load_dwordx4 v50, s[12:15], s8 offen offset:2048 lds
  buffer_load_dwordx4 v51, s[12:15], s8 offen offset:3072 lds
  s_waitcnt lgkmcnt(11)
  v_lshlrev_b32 v108, 16, v32
  v_and_b32 v109, 0xffff0000, v32
  v_lshlrev_b32 v110, 16, v33
  v_and_b32 v111, 0xffff0000, v33
  v_lshlrev_b32 v112, 16, v34
  v_and_b32 v113, 0xffff0000, v34
  v_lshlrev_b32 v114, 16, v35
  v_and_b32 v115, 0xffff0000, v35
  v_fmac_f32 v92, v108, v108
  v_fmac_f32 v93, v109, v109
  v_fmac_f32 v94, v110, v110
  v_fmac_f32 v95, v111, v111
  v_fmac_f32 v96, v112, v112
  v_fmac_f32 v97, v113, v113
  v_fmac_f32 v98, v114, v114
  v_fmac_f32 v99, v115, v115
  v_mfma_f32_16x16x32_bf16 v[100:103], v[52:55], v[32:35], v[100:103]
  v_mfma_f32_16x16x32_bf16 v[56:59], v[52:55], v[60:63], 0
  s_waitcnt lgkmcnt(10)
  v_lshlrev_b32 v108, 16, v36
  v_and_b32 v109, 0xffff0000, v36
  v_lshlrev_b32 v110, 16, v37
  v_and_b32 v111, 0xffff0000, v37
  v_lshlrev_b32 v112, 16, v38
  v_and_b32 v113, 0xffff0000, v38
  v_lshlrev_b32 v114, 16, v39
  v_and_b32 v115, 0xffff0000, v39
  v_fmac_f32 v92, v108, v108
  v_fmac_f32 v93, v109, v109
  v_fmac_f32 v94, v110, v110
  v_fmac_f32 v95, v111, v111
  v_fmac_f32 v96, v112, v112
  v_fmac_f32 v97, v113, v113
  v_fmac_f32 v98, v114, v114
  v_fmac_f32 v99, v115, v115
  v_mfma_f32_16x16x32_bf16 v[100:103], v[52:55], v[36:39], v[100:103]
  v_mfma_f32_16x16x32_bf16 v[56:59], v[52:55], v[64:67], v[56:59]
  s_waitcnt vmcnt(21)
  ds_read_b128 v[16:19], v8 offset:32768
  ds_read_b128 v[20:23], v9 offset:32768
  ds_read_b128 v[24:27], v10 offset:32768
  ds_read_b128 v[28:31], v11 offset:32768
  s_waitcnt lgkmcnt(13)
  v_lshlrev_b32 v108, 16, v40
  v_and_b32 v109, 0xffff0000, v40
  v_lshlrev_b32 v110, 16, v41
  v_and_b32 v111, 0xffff0000, v41
  v_lshlrev_b32 v112, 16, v42
  v_and_b32 v113, 0xffff0000, v42
  v_lshlrev_b32 v114, 16, v43
  v_and_b32 v115, 0xffff0000, v43
  v_fmac_f32 v92, v108, v108
  v_fmac_f32 v93, v109, v109
  v_fmac_f32 v94, v110, v110
  v_fmac_f32 v95, v111, v111
  v_fmac_f32 v96, v112, v112
  v_fmac_f32 v97, v113, v113
  v_fmac_f32 v98, v114, v114
  v_fmac_f32 v99, v115, v115
  v_mfma_f32_16x16x32_bf16 v[100:103], v[52:55], v[40:43], v[100:103]
  v_mfma_f32_16x16x32_bf16 v[56:59], v[52:55], v[68:71], v[56:59]
  s_waitcnt lgkmcnt(12)
  v_lshlrev_b32 v108, 16, v44
  v_and_b32 v109, 0xffff0000, v44
  v_lshlrev_b32 v110, 16, v45
  v_and_b32 v111, 0xffff0000, v45
  v_lshlrev_b32 v112, 16, v46
  v_and_b32 v113, 0xffff0000, v46
  v_lshlrev_b32 v114, 16, v47
  v_and_b32 v115, 0xffff0000, v47
  v_fmac_f32 v92, v108, v108
  v_fmac_f32 v93, v109, v109
  v_fmac_f32 v94, v110, v110
  v_fmac_f32 v95, v111, v111
  v_fmac_f32 v96, v112, v112
  v_fmac_f32 v97, v113, v113
  v_fmac_f32 v98, v114, v114
  v_fmac_f32 v99, v115, v115
  v_mfma_f32_16x16x32_bf16 v[100:103], v[52:55], v[44:47], v[100:103]
  v_mfma_f32_16x16x32_bf16 v[56:59], v[52:55], v[72:75], v[56:59]
  s_barrier
  ds_read_b64_tr_b16 v[60:61], v12 offset:24576
  ds_read_b64_tr_b16 v[62:63], v12 offset:25344
  ds_read_b64_tr_b16 v[64:65], v12 offset:27648
  ds_read_b64_tr_b16 v[66:67], v12 offset:28416
  ds_read_b64_tr_b16 v[68:69], v12 offset:30720
  ds_read_b64_tr_b16 v[70:71], v12 offset:31488
  ds_read_b64_tr_b16 v[72:73], v12 offset:33792
  ds_read_b64_tr_b16 v[74:75], v12 offset:34560
  s_add_u32 m0, s25, 0x4000
  s_add_u32 s8, s28, 6
  s_and_b32 s8, s8, 7
  s_lshl_b32 s8, s8, 7
  s_add_u32 s8, s8, s24
  buffer_load_dwordx4 v48, s[12:15], s8 offen offset:0 lds
  buffer_load_dwordx4 v49, s[12:15], s8 offen offset:1024 lds
  buffer_load_dwordx4 v50, s[12:15], s8 offen offset:2048 lds
  buffer_load_dwordx4 v51, s[12:15], s8 offen offset:3072 lds
  s_add_u32 m0, s27, 0
  s_add_u32 s8, s28, 6
  s_and_b32 s8, s8, 7
  s_mul_i32 s8, s8, 0x30000
  s_add_u32 s8, s8, s26
  buffer_load_dwordx4 v5, s[16:19], s8 offen offset:0 lds
  buffer_load_dwordx4 v6, s[16:19], s8 offen offset:1024 lds
  buffer_load_dwordx4 v7, s[16:19], s8 offen offset:2048 lds
  s_waitcnt lgkmcnt(11)
  v_lshlrev_b32 v108, 16, v16
  v_and_b32 v109, 0xffff0000, v16
  v_lshlrev_b32 v110, 16, v17
  v_and_b32 v111, 0xffff0000, v17
  v_lshlrev_b32 v112, 16, v18
  v_and_b32 v113, 0xffff0000, v18
  v_lshlrev_b32 v114, 16, v19
  v_and_b32 v115, 0xffff0000, v19
  v_fmac_f32 v92, v108, v108
  v_fmac_f32 v93, v109, v109
  v_fmac_f32 v94, v110, v110
  v_fmac_f32 v95, v111, v111
  v_fmac_f32 v96, v112, v112
  v_fmac_f32 v97, v113, v113
  v_fmac_f32 v98, v114, v114
  v_fmac_f32 v99, v115, v115
  v_mfma_f32_16x16x32_bf16 v[100:103], v[52:55], v[16:19], v[100:103]
  v_mfma_f32_16x16x32_bf16 v[56:59], v[52:55], v[76:79], v[56:59]
  s_waitcnt lgkmcnt(10)
  v_lshlrev_b32 v108, 16, v20
  v_and_b32 v109, 0xffff0000, v20
  v_lshlrev_b32 v110, 16, v21
  v_and_b32 v111, 0xffff0000, v21
  v_lshlrev_b32 v112, 16, v22
  v_and_b32 v113, 0xffff0000, v22
  v_lshlrev_b32 v114, 16, v23
  v_and_b32 v115, 0xffff0000, v23
  v_fmac_f32 v92, v108, v108
  v_fmac_f32 v93, v109, v109
  v_fmac_f32 v94, v110, v110
  v_fmac_f32 v95, v111, v111
  v_fmac_f32 v96, v112, v112
  v_fmac_f32 v97, v113, v113
  v_fmac_f32 v98, v114, v114
  v_fmac_f32 v99, v115, v115
  v_mfma_f32_16x16x32_bf16 v[100:103], v[52:55], v[20:23], v[100:103]
  v_mfma_f32_16x16x32_bf16 v[56:59], v[52:55], v[80:83], v[56:59]
  s_waitcnt vmcnt(24)
  ds_read_b128 v[32:35], v8 offset:49152
  ds_read_b128 v[36:39], v9 offset:49152
  ds_read_b128 v[40:43], v10 offset:49152
  ds_read_b128 v[44:47], v11 offset:49152
  s_waitcnt lgkmcnt(13)
  v_lshlrev_b32 v108, 16, v24
  v_and_b32 v109, 0xffff0000, v24
  v_lshlrev_b32 v110, 16, v25
  v_and_b32 v111, 0xffff0000, v25
  v_lshlrev_b32 v112, 16, v26
  v_and_b32 v113, 0xffff0000, v26
  v_lshlrev_b32 v114, 16, v27
  v_and_b32 v115, 0xffff0000, v27
  v_fmac_f32 v92, v108, v108
  v_fmac_f32 v93, v109, v109
  v_fmac_f32 v94, v110, v110
  v_fmac_f32 v95, v111, v111
  v_fmac_f32 v96, v112, v112
  v_fmac_f32 v97, v113, v113
  v_fmac_f32 v98, v114, v114
  v_fmac_f32 v99, v115, v115
  v_mfma_f32_16x16x32_bf16 v[100:103], v[52:55], v[24:27], v[100:103]
  v_mfma_f32_16x16x32_bf16 v[56:59], v[52:55], v[84:87], v[56:59]
  s_waitcnt lgkmcnt(12)
  v_lshlrev_b32 v108, 16, v28
  v_and_b32 v109, 0xffff0000, v28
  v_lshlrev_b32 v110, 16, v29
  v_and_b32 v111, 0xffff0000, v29
  v_lshlrev_b32 v112, 16, v30
  v_and_b32 v113, 0xffff0000, v30
  v_lshlrev_b32 v114, 16, v31
  v_and_b32 v115, 0xffff0000, v31
  v_fmac_f32 v92, v108, v108
  v_fmac_f32 v93, v109, v109
  v_fmac_f32 v94, v110, v110
  v_fmac_f32 v95, v111, v111
  v_fmac_f32 v96, v112, v112
  v_fmac_f32 v97, v113, v113
  v_fmac_f32 v98, v114, v114
  v_fmac_f32 v99, v115, v115
  v_mfma_f32_16x16x32_bf16 v[100:103], v[52:55], v[28:31], v[100:103]
  v_mfma_f32_16x16x32_bf16 v[56:59], v[52:55], v[88:91], v[56:59]
  s_waitcnt vmcnt(21)
  s_barrier
  ds_read_b64_tr_b16 v[76:77], v12 offset:36864
  ds_read_b64_tr_b16 v[78:79], v12 offset:37632
  ds_read_b64_tr_b16 v[80:81], v12 offset:39936
  ds_read_b64_tr_b16 v[82:83], v12 offset:40704
  ds_read_b64_tr_b16 v[84:85], v12 offset:43008
  ds_read_b64_tr_b16 v[86:87], v12 offset:43776
  ds_read_b64_tr_b16 v[88:89], v12 offset:46080
  ds_read_b64_tr_b16 v[90:91], v12 offset:46848
  s_add_u32 m0, s25, 0x8000
  s_add_u32 s8, s28, 7
  s_and_b32 s8, s8, 7
  s_lshl_b32 s8, s8, 7
  s_add_u32 s8, s8, s24
  buffer_load_dwordx4 v48, s[12:15], s8 offen offset:0 lds
  buffer_load_dwordx4 v49, s[12:15], s8 offen offset:1024 lds
  buffer_load_dwordx4 v50, s[12:15], s8 offen offset:2048 lds
  buffer_load_dwordx4 v51, s[12:15], s8 offen offset:3072 lds
  s_add_u32 m0, s27, 0x3000
  s_add_u32 s8, s28, 7
  s_and_b32 s8, s8, 7
  s_mul_i32 s8, s8, 0x30000
  s_add_u32 s8, s8, s26
  buffer_load_dwordx4 v5, s[16:19], s8 offen offset:0 lds
  buffer_load_dwordx4 v6, s[16:19], s8 offen offset:1024 lds
  buffer_load_dwordx4 v7, s[16:19], s8 offen offset:2048 lds
  s_and_b32 s8, s2, 7
  s_lshl_b32 s8, s8, 12
  s_and_b32 s9, s2, 16
  s_lshl_b32 s9, s9, 7
  s_add_u32 s8, s8, s9
  s_add_u32 s8, s8, 0xa00000
  v_and_b32 v249, 60, v1
  v_lshl_add_u32 v248, v249, 5, s8
  v_and_b32 v249, 3, v1
  v_lshl_add_u32 v248, v249, 2, v248
  buffer_load_dword v249, v248, s[20:23], 0 offen sc1
  s_waitcnt lgkmcnt(11)
  v_lshlrev_b32 v108, 16, v32
  v_and_b32 v109, 0xffff0000, v32
  v_lshlrev_b32 v110, 16, v33
  v_and_b32 v111, 0xffff0000, v33
  v_lshlrev_b32 v112, 16, v34
  v_and_b32 v113, 0xffff0000, v34
  v_lshlrev_b32 v114, 16, v35
  v_and_b32 v115, 0xffff0000, v35
  v_fmac_f32 v92, v108, v108
  v_fmac_f32 v93, v109, v109
  v_fmac_f32 v94, v110, v110
  v_fmac_f32 v95, v111, v111
  v_fmac_f32 v96, v112, v112
  v_fmac_f32 v97, v113, v113
  v_fmac_f32 v98, v114, v114
  v_fmac_f32 v99, v115, v115
  v_mfma_f32_16x16x32_bf16 v[100:103], v[52:55], v[32:35], v[100:103]
  v_mfma_f32_16x16x32_bf16 v[56:59], v[52:55], v[60:63], v[56:59]
  s_waitcnt lgkmcnt(10)
  v_lshlrev_b32 v108, 16, v36
  v_and_b32 v109, 0xffff0000, v36
  v_lshlrev_b32 v110, 16, v37
  v_and_b32 v111, 0xffff0000, v37
  v_lshlrev_b32 v112, 16, v38
  v_and_b32 v113, 0xffff0000, v38
  v_lshlrev_b32 v114, 16, v39
  v_and_b32 v115, 0xffff0000, v39
  v_fmac_f32 v92, v108, v108
  v_fmac_f32 v93, v109, v109
  v_fmac_f32 v94, v110, v110
  v_fmac_f32 v95, v111, v111
  v_fmac_f32 v96, v112, v112
  v_fmac_f32 v97, v113, v113
  v_fmac_f32 v98, v114, v114
  v_fmac_f32 v99, v115, v115
  v_mfma_f32_16x16x32_bf16 v[100:103], v[52:55], v[36:39], v[100:103]
  v_mfma_f32_16x16x32_bf16 v[56:59], v[52:55], v[64:67], v[56:59]
  s_waitcnt vmcnt(25)
  v_add_u32 v8, 0x10000, v8
  v_add_u32 v9, 0x10000, v9
  v_add_u32 v10, 0x10000, v10
  v_add_u32 v11, 0x10000, v11
  ds_read_b128 v[16:19], v8 offset:0
  ds_read_b128 v[20:23], v9 offset:0
  ds_read_b128 v[24:27], v10 offset:0
  ds_read_b128 v[28:31], v11 offset:0
  s_waitcnt lgkmcnt(13)
  v_lshlrev_b32 v108, 16, v40
  v_and_b32 v109, 0xffff0000, v40
  v_lshlrev_b32 v110, 16, v41
  v_and_b32 v111, 0xffff0000, v41
  v_lshlrev_b32 v112, 16, v42
  v_and_b32 v113, 0xffff0000, v42
  v_lshlrev_b32 v114, 16, v43
  v_and_b32 v115, 0xffff0000, v43
  v_fmac_f32 v92, v108, v108
  v_fmac_f32 v93, v109, v109
  v_fmac_f32 v94, v110, v110
  v_fmac_f32 v95, v111, v111
  v_fmac_f32 v96, v112, v112
  v_fmac_f32 v97, v113, v113
  v_fmac_f32 v98, v114, v114
  v_fmac_f32 v99, v115, v115
  v_mfma_f32_16x16x32_bf16 v[100:103], v[52:55], v[40:43], v[100:103]
  v_mfma_f32_16x16x32_bf16 v[56:59], v[52:55], v[68:71], v[56:59]
  s_waitcnt lgkmcnt(12)
  v_lshlrev_b32 v108, 16, v44
  v_and_b32 v109, 0xffff0000, v44
  v_lshlrev_b32 v110, 16, v45
  v_and_b32 v111, 0xffff0000, v45
  v_lshlrev_b32 v112, 16, v46
  v_and_b32 v113, 0xffff0000, v46
  v_lshlrev_b32 v114, 16, v47
  v_and_b32 v115, 0xffff0000, v47
  v_fmac_f32 v92, v108, v108
  v_fmac_f32 v93, v109, v109
  v_fmac_f32 v94, v110, v110
  v_fmac_f32 v95, v111, v111
  v_fmac_f32 v96, v112, v112
  v_fmac_f32 v97, v113, v113
  v_fmac_f32 v98, v114, v114
  v_fmac_f32 v99, v115, v115
  v_mfma_f32_16x16x32_bf16 v[100:103], v[52:55], v[44:47], v[100:103]
  v_mfma_f32_16x16x32_bf16 v[56:59], v[52:55], v[72:75], v[56:59]
  s_waitcnt vmcnt(22)
  s_barrier
  v_add_u32 v12, 0xc000, v12
  ds_read_b64_tr_b16 v[60:61], v12 offset:0
  ds_read_b64_tr_b16 v[62:63], v12 offset:768
  ds_read_b64_tr_b16 v[64:65], v12 offset:3072
  ds_read_b64_tr_b16 v[66:67], v12 offset:3840
  ds_read_b64_tr_b16 v[68:69], v12 offset:6144
  ds_read_b64_tr_b16 v[70:71], v12 offset:6912
  ds_read_b64_tr_b16 v[72:73], v12 offset:9216
  ds_read_b64_tr_b16 v[74:75], v12 offset:9984
  s_waitcnt lgkmcnt(11)
  v_lshlrev_b32 v108, 16, v16
  v_and_b32 v109, 0xffff0000, v16
  v_lshlrev_b32 v110, 16, v17
  v_and_b32 v111, 0xffff0000, v17
  v_lshlrev_b32 v112, 16, v18
  v_and_b32 v113, 0xffff0000, v18
  v_lshlrev_b32 v114, 16, v19
  v_and_b32 v115, 0xffff0000, v19
  v_fmac_f32 v92, v108, v108
  v_fmac_f32 v93, v109, v109
  v_fmac_f32 v94, v110, v110
  v_fmac_f32 v95, v111, v111
  v_fmac_f32 v96, v112, v112
  v_fmac_f32 v97, v113, v113
  v_fmac_f32 v98, v114, v114
  v_fmac_f32 v99, v115, v115
  v_mfma_f32_16x16x32_bf16 v[100:103], v[52:55], v[16:19], v[100:103]
  v_mfma_f32_16x16x32_bf16 v[56:59], v[52:55], v[76:79], v[56:59]
  s_waitcnt lgkmcnt(10)
  v_lshlrev_b32 v108, 16, v20
  v_and_b32 v109, 0xffff0000, v20
  v_lshlrev_b32 v110, 16, v21
  v_and_b32 v111, 0xffff0000, v21
  v_lshlrev_b32 v112, 16, v22
  v_and_b32 v113, 0xffff0000, v22
  v_lshlrev_b32 v114, 16, v23
  v_and_b32 v115, 0xffff0000, v23
  v_fmac_f32 v92, v108, v108
  v_fmac_f32 v93, v109, v109
  v_fmac_f32 v94, v110, v110
  v_fmac_f32 v95, v111, v111
  v_fmac_f32 v96, v112, v112
  v_fmac_f32 v97, v113, v113
  v_fmac_f32 v98, v114, v114
  v_fmac_f32 v99, v115, v115
  v_mfma_f32_16x16x32_bf16 v[100:103], v[52:55], v[20:23], v[100:103]
  v_mfma_f32_16x16x32_bf16 v[56:59], v[52:55], v[80:83], v[56:59]
  s_waitcnt vmcnt(15)
  v_subrev_u32 v8, 0x10000, v8
  v_subrev_u32 v9, 0x10000, v9
  v_subrev_u32 v10, 0x10000, v10
  v_subrev_u32 v11, 0x10000, v11
  ds_read_b128 v[32:35], v8 offset:0
  ds_read_b128 v[36:39], v9 offset:0
  ds_read_b128 v[40:43], v10 offset:0
  ds_read_b128 v[44:47], v11 offset:0
  s_waitcnt lgkmcnt(13)
  v_lshlrev_b32 v108, 16, v24
  v_and_b32 v109, 0xffff0000, v24
  v_lshlrev_b32 v110, 16, v25
  v_and_b32 v111, 0xffff0000, v25
  v_lshlrev_b32 v112, 16, v26
  v_and_b32 v113, 0xffff0000, v26
  v_lshlrev_b32 v114, 16, v27
  v_and_b32 v115, 0xffff0000, v27
  v_fmac_f32 v92, v108, v108
  v_fmac_f32 v93, v109, v109
  v_fmac_f32 v94, v110, v110
  v_fmac_f32 v95, v111, v111
  v_fmac_f32 v96, v112, v112
  v_fmac_f32 v97, v113, v113
  v_fmac_f32 v98, v114, v114
  v_fmac_f32 v99, v115, v115
  v_mfma_f32_16x16x32_bf16 v[100:103], v[52:55], v[24:27], v[100:103]
  v_mfma_f32_16x16x32_bf16 v[56:59], v[52:55], v[84:87], v[56:59]
  s_waitcnt lgkmcnt(12)
  v_lshlrev_b32 v108, 16, v28
  v_and_b32 v109, 0xffff0000, v28
  v_lshlrev_b32 v110, 16, v29
  v_and_b32 v111, 0xffff0000, v29
  v_lshlrev_b32 v112, 16, v30
  v_and_b32 v113, 0xffff0000, v30
  v_lshlrev_b32 v114, 16, v31
  v_and_b32 v115, 0xffff0000, v31
  v_fmac_f32 v92, v108, v108
  v_fmac_f32 v93, v109, v109
  v_fmac_f32 v94, v110, v110
  v_fmac_f32 v95, v111, v111
  v_fmac_f32 v96, v112, v112
  v_fmac_f32 v97, v113, v113
  v_fmac_f32 v98, v114, v114
  v_fmac_f32 v99, v115, v115
  v_mfma_f32_16x16x32_bf16 v[100:103], v[52:55], v[28:31], v[100:103]
  v_mfma_f32_16x16x32_bf16 v[56:59], v[52:55], v[88:91], v[56:59]
  s_barrier
  ds_read_b64_tr_b16 v[76:77], v12 offset:12288
  ds_read_b64_tr_b16 v[78:79], v12 offset:13056
  ds_read_b64_tr_b16 v[80:81], v12 offset:15360
  ds_read_b64_tr_b16 v[82:83], v12 offset:16128
  ds_read_b64_tr_b16 v[84:85], v12 offset:18432
  ds_read_b64_tr_b16 v[86:87], v12 offset:19200
  ds_read_b64_tr_b16 v[88:89], v12 offset:21504
  ds_read_b64_tr_b16 v[90:91], v12 offset:22272
  s_waitcnt lgkmcnt(11)
  v_lshlrev_b32 v108, 16, v32
  v_and_b32 v109, 0xffff0000, v32
  v_lshlrev_b32 v110, 16, v33
  v_and_b32 v111, 0xffff0000, v33
  v_lshlrev_b32 v112, 16, v34
  v_and_b32 v113, 0xffff0000, v34
  v_lshlrev_b32 v114, 16, v35
  v_and_b32 v115, 0xffff0000, v35
  v_fmac_f32 v92, v108, v108
  v_fmac_f32 v93, v109, v109
  v_fmac_f32 v94, v110, v110
  v_fmac_f32 v95, v111, v111
  v_fmac_f32 v96, v112, v112
  v_fmac_f32 v97, v113, v113
  v_fmac_f32 v98, v114, v114
  v_fmac_f32 v99, v115, v115
  v_mfma_f32_16x16x32_bf16 v[100:103], v[52:55], v[32:35], v[100:103]
  v_mfma_f32_16x16x32_bf16 v[56:59], v[52:55], v[60:63], v[56:59]
  s_waitcnt lgkmcnt(10)
  v_lshlrev_b32 v108, 16, v36
  v_and_b32 v109, 0xffff0000, v36
  v_lshlrev_b32 v110, 16, v37
  v_and_b32 v111, 0xffff0000, v37
  v_lshlrev_b32 v112, 16, v38
  v_and_b32 v113, 0xffff0000, v38
  v_lshlrev_b32 v114, 16, v39
  v_and_b32 v115, 0xffff0000, v39
  v_fmac_f32 v92, v108, v108
  v_fmac_f32 v93, v109, v109
  v_fmac_f32 v94, v110, v110
  v_fmac_f32 v95, v111, v111
  v_fmac_f32 v96, v112, v112
  v_fmac_f32 v97, v113, v113
  v_fmac_f32 v98, v114, v114
  v_fmac_f32 v99, v115, v115
  v_mfma_f32_16x16x32_bf16 v[100:103], v[52:55], v[36:39], v[100:103]
  v_mfma_f32_16x16x32_bf16 v[56:59], v[52:55], v[64:67], v[56:59]
  s_waitcnt vmcnt(11)
  ds_read_b128 v[16:19], v8 offset:16384
  ds_read_b128 v[20:23], v9 offset:16384
  ds_read_b128 v[24:27], v10 offset:16384
  ds_read_b128 v[28:31], v11 offset:16384
  s_waitcnt lgkmcnt(13)
  v_lshlrev_b32 v108, 16, v40
  v_and_b32 v109, 0xffff0000, v40
  v_lshlrev_b32 v110, 16, v41
  v_and_b32 v111, 0xffff0000, v41
  v_lshlrev_b32 v112, 16, v42
  v_and_b32 v113, 0xffff0000, v42
  v_lshlrev_b32 v114, 16, v43
  v_and_b32 v115, 0xffff0000, v43
  v_fmac_f32 v92, v108, v108
  v_fmac_f32 v93, v109, v109
  v_fmac_f32 v94, v110, v110
  v_fmac_f32 v95, v111, v111
  v_fmac_f32 v96, v112, v112
  v_fmac_f32 v97, v113, v113
  v_fmac_f32 v98, v114, v114
  v_fmac_f32 v99, v115, v115
  v_mfma_f32_16x16x32_bf16 v[100:103], v[52:55], v[40:43], v[100:103]
  v_mfma_f32_16x16x32_bf16 v[56:59], v[52:55], v[68:71], v[56:59]
  s_waitcnt lgkmcnt(12)
  v_lshlrev_b32 v108, 16, v44
  v_and_b32 v109, 0xffff0000, v44
  v_lshlrev_b32 v110, 16, v45
  v_and_b32 v111, 0xffff0000, v45
  v_lshlrev_b32 v112, 16, v46
  v_and_b32 v113, 0xffff0000, v46
  v_lshlrev_b32 v114, 16, v47
  v_and_b32 v115, 0xffff0000, v47
  v_fmac_f32 v92, v108, v108
  v_fmac_f32 v93, v109, v109
  v_fmac_f32 v94, v110, v110
  v_fmac_f32 v95, v111, v111
  v_fmac_f32 v96, v112, v112
  v_fmac_f32 v97, v113, v113
  v_fmac_f32 v98, v114, v114
  v_fmac_f32 v99, v115, v115
  v_mfma_f32_16x16x32_bf16 v[100:103], v[52:55], v[44:47], v[100:103]
  v_mfma_f32_16x16x32_bf16 v[56:59], v[52:55], v[72:75], v[56:59]
  s_waitcnt vmcnt(8)
  s_barrier
  v_subrev_u32 v12, 0xc000, v12
  ds_read_b64_tr_b16 v[60:61], v12 offset:0
  ds_read_b64_tr_b16 v[62:63], v12 offset:768
  ds_read_b64_tr_b16 v[64:65], v12 offset:3072
  ds_read_b64_tr_b16 v[66:67], v12 offset:3840
  ds_read_b64_tr_b16 v[68:69], v12 offset:6144
  ds_read_b64_tr_b16 v[70:71], v12 offset:6912
  ds_read_b64_tr_b16 v[72:73], v12 offset:9216
  ds_read_b64_tr_b16 v[74:75], v12 offset:9984
  s_waitcnt lgkmcnt(11)
  v_lshlrev_b32 v108, 16, v16
  v_and_b32 v109, 0xffff0000, v16
  v_lshlrev_b32 v110, 16, v17
  v_and_b32 v111, 0xffff0000, v17
  v_lshlrev_b32 v112, 16, v18
  v_and_b32 v113, 0xffff0000, v18
  v_lshlrev_b32 v114, 16, v19
  v_and_b32 v115, 0xffff0000, v19
  v_fmac_f32 v92, v108, v108
  v_fmac_f32 v93, v109, v109
  v_fmac_f32 v94, v110, v110
  v_fmac_f32 v95, v111, v111
  v_fmac_f32 v96, v112, v112
  v_fmac_f32 v97, v113, v113
  v_fmac_f32 v98, v114, v114
  v_fmac_f32 v99, v115, v115
  v_mfma_f32_16x16x32_bf16 v[100:103], v[52:55], v[16:19], v[100:103]
  v_mfma_f32_16x16x32_bf16 v[56:59], v[52:55], v[76:79], v[56:59]
  s_waitcnt lgkmcnt(10)
  v_lshlrev_b32 v108, 16, v20
  v_and_b32 v109, 0xffff0000, v20
  v_lshlrev_b32 v110, 16, v21
  v_and_b32 v111, 0xffff0000, v21
  v_lshlrev_b32 v112, 16, v22
  v_and_b32 v113, 0xffff0000, v22
  v_lshlrev_b32 v114, 16, v23
  v_and_b32 v115, 0xffff0000, v23
  v_fmac_f32 v92, v108, v108
  v_fmac_f32 v93, v109, v109
  v_fmac_f32 v94, v110, v110
  v_fmac_f32 v95, v111, v111
  v_fmac_f32 v96, v112, v112
  v_fmac_f32 v97, v113, v113
  v_fmac_f32 v98, v114, v114
  v_fmac_f32 v99, v115, v115
  v_mfma_f32_16x16x32_bf16 v[100:103], v[52:55], v[20:23], v[100:103]
  v_mfma_f32_16x16x32_bf16 v[56:59], v[52:55], v[80:83], v[56:59]
  s_waitcnt vmcnt(4)
  ds_read_b128 v[32:35], v8 offset:32768
  ds_read_b128 v[36:39], v9 offset:32768
  ds_read_b128 v[40:43], v10 offset:32768
  ds_read_b128 v[44:47], v11 offset:32768
  s_waitcnt lgkmcnt(13)
  v_lshlrev_b32 v108, 16, v24
  v_and_b32 v109, 0xffff0000, v24
  v_lshlrev_b32 v110, 16, v25
  v_and_b32 v111, 0xffff0000, v25
  v_lshlrev_b32 v112, 16, v26
  v_and_b32 v113, 0xffff0000, v26
  v_lshlrev_b32 v114, 16, v27
  v_and_b32 v115, 0xffff0000, v27
  v_fmac_f32 v92, v108, v108
  v_fmac_f32 v93, v109, v109
  v_fmac_f32 v94, v110, v110
  v_fmac_f32 v95, v111, v111
  v_fmac_f32 v96, v112, v112
  v_fmac_f32 v97, v113, v113
  v_fmac_f32 v98, v114, v114
  v_fmac_f32 v99, v115, v115
  v_mfma_f32_16x16x32_bf16 v[100:103], v[52:55], v[24:27], v[100:103]
  v_mfma_f32_16x16x32_bf16 v[56:59], v[52:55], v[84:87], v[56:59]
  s_waitcnt lgkmcnt(12)
  v_lshlrev_b32 v108, 16, v28
  v_and_b32 v109, 0xffff0000, v28
  v_lshlrev_b32 v110, 16, v29
  v_and_b32 v111, 0xffff0000, v29
  v_lshlrev_b32 v112, 16, v30
  v_and_b32 v113, 0xffff0000, v30
  v_lshlrev_b32 v114, 16, v31
  v_and_b32 v115, 0xffff0000, v31
  v_fmac_f32 v92, v108, v108
  v_fmac_f32 v93, v109, v109
  v_fmac_f32 v94, v110, v110
  v_fmac_f32 v95, v111, v111
  v_fmac_f32 v96, v112, v112
  v_fmac_f32 v97, v113, v113
  v_fmac_f32 v98, v114, v114
  v_fmac_f32 v99, v115, v115
  v_mfma_f32_16x16x32_bf16 v[100:103], v[52:55], v[28:31], v[100:103]
  v_mfma_f32_16x16x32_bf16 v[56:59], v[52:55], v[88:91], v[56:59]
  s_waitcnt vmcnt(1)
  s_barrier
  ds_read_b64_tr_b16 v[76:77], v12 offset:12288
  ds_read_b64_tr_b16 v[78:79], v12 offset:13056
  ds_read_b64_tr_b16 v[80:81], v12 offset:15360
  ds_read_b64_tr_b16 v[82:83], v12 offset:16128
  ds_read_b64_tr_b16 v[84:85], v12 offset:18432
  ds_read_b64_tr_b16 v[86:87], v12 offset:19200
  ds_read_b64_tr_b16 v[88:89], v12 offset:21504
  ds_read_b64_tr_b16 v[90:91], v12 offset:22272
  s_waitcnt lgkmcnt(11)
  v_lshlrev_b32 v108, 16, v32
  v_and_b32 v109, 0xffff0000, v32
  v_lshlrev_b32 v110, 16, v33
  v_and_b32 v111, 0xffff0000, v33
  v_lshlrev_b32 v112, 16, v34
  v_and_b32 v113, 0xffff0000, v34
  v_lshlrev_b32 v114, 16, v35
  v_and_b32 v115, 0xffff0000, v35
  v_fmac_f32 v92, v108, v108
  v_fmac_f32 v93, v109, v109
  v_fmac_f32 v94, v110, v110
  v_fmac_f32 v95, v111, v111
  v_fmac_f32 v96, v112, v112
  v_fmac_f32 v97, v113, v113
  v_fmac_f32 v98, v114, v114
  v_fmac_f32 v99, v115, v115
  v_mfma_f32_16x16x32_bf16 v[100:103], v[52:55], v[32:35], v[100:103]
  v_mfma_f32_16x16x32_bf16 v[56:59], v[52:55], v[60:63], v[56:59]
  s_waitcnt lgkmcnt(10)
  v_lshlrev_b32 v108, 16, v36
  v_and_b32 v109, 0xffff0000, v36
  v_lshlrev_b32 v110, 16, v37
  v_and_b32 v111, 0xffff0000, v37
  v_lshlrev_b32 v112, 16, v38
  v_and_b32 v113, 0xffff0000, v38
  v_lshlrev_b32 v114, 16, v39
  v_and_b32 v115, 0xffff0000, v39
  v_fmac_f32 v92, v108, v108
  v_fmac_f32 v93, v109, v109
  v_fmac_f32 v94, v110, v110
  v_fmac_f32 v95, v111, v111
  v_fmac_f32 v96, v112, v112
  v_fmac_f32 v97, v113, v113
  v_fmac_f32 v98, v114, v114
  v_fmac_f32 v99, v115, v115
  v_mfma_f32_16x16x32_bf16 v[100:103], v[52:55], v[36:39], v[100:103]
  v_mfma_f32_16x16x32_bf16 v[56:59], v[52:55], v[64:67], v[56:59]
  s_waitcnt lgkmcnt(9)
  v_lshlrev_b32 v108, 16, v40
  v_and_b32 v109, 0xffff0000, v40
  v_lshlrev_b32 v110, 16, v41
  v_and_b32 v111, 0xffff0000, v41
  v_lshlrev_b32 v112, 16, v42
  v_and_b32 v113, 0xffff0000, v42
  v_lshlrev_b32 v114, 16, v43
  v_and_b32 v115, 0xffff0000, v43
  v_fmac_f32 v92, v108, v108
  v_fmac_f32 v93, v109, v109
  v_fmac_f32 v94, v110, v110
  v_fmac_f32 v95, v111, v111
  v_fmac_f32 v96, v112, v112
  v_fmac_f32 v97, v113, v113
  v_fmac_f32 v98, v114, v114
  v_fmac_f32 v99, v115, v115
  v_mfma_f32_16x16x32_bf16 v[100:103], v[52:55], v[40:43], v[100:103]
  v_mfma_f32_16x16x32_bf16 v[56:59], v[52:55], v[68:71], v[56:59]
  s_waitcnt lgkmcnt(8)
  v_lshlrev_b32 v108, 16, v44
  v_and_b32 v109, 0xffff0000, v44
  v_lshlrev_b32 v110, 16, v45
  v_and_b32 v111, 0xffff0000, v45
  v_lshlrev_b32 v112, 16, v46
  v_and_b32 v113, 0xffff0000, v46
  v_lshlrev_b32 v114, 16, v47
  v_and_b32 v115, 0xffff0000, v47
  v_fmac_f32 v92, v108, v108
  v_fmac_f32 v93, v109, v109
  v_fmac_f32 v94, v110, v110
  v_fmac_f32 v95, v111, v111
  v_fmac_f32 v96, v112, v112
  v_fmac_f32 v97, v113, v113
  v_fmac_f32 v98, v114, v114
  v_fmac_f32 v99, v115, v115
  v_mfma_f32_16x16x32_bf16 v[100:103], v[52:55], v[44:47], v[100:103]
  v_mfma_f32_16x16x32_bf16 v[56:59], v[52:55], v[72:75], v[56:59]
  s_waitcnt lgkmcnt(6)
  v_mfma_f32_16x16x32_bf16 v[56:59], v[52:55], v[76:79], v[56:59]
  s_waitcnt lgkmcnt(4)
  v_mfma_f32_16x16x32_bf16 v[56:59], v[52:55], v[80:83], v[56:59]
  s_waitcnt lgkmcnt(2)
  v_mfma_f32_16x16x32_bf16 v[56:59], v[52:55], v[84:87], v[56:59]
  s_waitcnt lgkmcnt(0)
  v_mfma_f32_16x16x32_bf16 v[56:59], v[52:55], v[88:91], v[56:59]
  v_add_f32 v92, v92, v93
  v_add_f32 v94, v94, v95
  v_add_f32 v96, v96, v97
  v_add_f32 v98, v98, v99
  v_add_f32 v92, v92, v94
  v_add_f32 v96, v96, v98
  v_add_f32 v92, v92, v96
  v_mov_b32 v93, v92
  v_mov_b32 v101, 0
  s_lshl_b32 s8, s7, 7
  s_add_u32 s8, s8, 0x12000
  v_lshl_add_u32 v2, v13, 2, s8
  v_permlane32_swap_b32 v92, v93
  v_add_f32 v92, v92, v93
  v_add_f32 v100, v100, v101
  v_mul_f32 v108, 0x3b000000, v100
  v_mul_f32 v109, v108, v108
  v_mov_b32 v110, 0x3b000000
  v_fma_f32 v109, v92, v110, -v109
  v_max_f32 v109, 0, v109
  v_add_f32 v109, 0x3727c5ac, v109
  v_rsq_f32 v110, v109
  v_mul_f32 v108, -0.5, v108
  v_cvt_pk_bf16_f32 v109, v108, v108
  v_and_b32 v109, 0xffff0000, v109
  v_sub_f32 v109, v108, v109
  v_cvt_pk_bf16_f32 v109, v108, v109
  ds_write_b32 v2, v110 offset:1024
  ds_write_b32 v2, v109 offset:1536
  s_min_u32 s8, s7, 2
  s_lshl_b32 s8, s8, 8
  s_add_u32 s8, s8, 0x12000
  v_lshl_add_u32 v2, v13, 3, s8
  v_cvt_pk_bf16_f32 v108, v56, v56
  v_and_b32 v109, 0xffff0000, v108
  v_sub_f32 v109, v56, v109
  v_cvt_pk_bf16_f32 v109, v109, v109
  ds_write_b64 v2, v[108:109]
  s_waitcnt lgkmcnt(0)
  s_barrier
k6_kernel_fin4:
  s_load_dwordx2 s[8:9], s[0:1], 64
  s_load_dwordx2 s[12:13], s[0:1], 16
  s_load_dwordx2 s[16:17], s[0:1], 32
  s_load_dwordx2 s[20:21], s[0:1], 40
  s_load_dwordx2 s[24:25], s[0:1], 0
  s_load_dwordx2 s[28:29], s[0:1], 48
  v_lshrrev_b32 v253, 6, v0
  v_and_b32 v1, 63, v0
  v_readfirstlane_b32 s6, v253
  v_lshlrev_b32 v1, 4, v1
  s_and_b32 s37, s2, 7
  s_lshr_b32 s38, s2, 3
  s_and_b32 s65, s38, 3
  s_lshl_b32 s7, s37, 2
  s_add_u32 s65, s65, s7
  s_lshr_b32 s39, s38, 2
  s_lshl_b32 s39, s39, 3
  s_add_u32 s39, s39, s6
  s_lshl_b32 s7, s65, 16
  s_lshl_b32 s36, s6, 10
  s_add_u32 s40, s7, s36
  s_add_u32 s40, s40, 0x200000
  s_and_b32 s76, s38, 7
  s_lshl_b32 s76, s76, 13
  s_add_u32 s41, s40, s76
  s_add_u32 s42, s41, 0x1ffc00
  s_lshl_b32 s36, s39, 10
  s_add_u32 s70, s7, s36
  s_mul_i32 s43, s6, 0x820
  s_mov_b32 s10, 0x1400000
  s_mov_b32 s11, 0x20000
  s_waitcnt lgkmcnt(0)
  s_getreg_b32 s53, hwreg(HW_REG_XCC_ID, 0, 4)
  s_mov_b32 s14, 0x80000
  s_mov_b32 s15, 0x20000
  s_mov_b32 s18, 0x1c0000
  s_mov_b32 s19, 0x20000
  s_mov_b32 s22, 0x1c0000
  s_mov_b32 s23, 0x20000
  s_mov_b32 s26, 0x200000
  s_mov_b32 s27, 0x20000
  s_mov_b32 s30, 0x200000
  s_mov_b32 s31, 0x20000
  s_mov_b32 s34, 0x1400000
  s_mov_b32 s35, 0x20000
  s_mov_b64 s[32:33], s[8:9]
  s_add_u32 s53, s53, 1
  s_mov_b32 s51, 0xdddddddd
  s_mov_b32 s52, 0
  s_mul_i32 s44, s6, 0x2100
  s_add_u32 s44, s44, 0x14500
  s_lshr_b32 s66, s38, 3
  s_and_b32 s67, s38, 7
  s_lshr_b32 s68, s38, 2
  s_and_b32 s7, s38, 3
  s_lshl_b32 s7, s7, 8
  s_and_b32 s36, s6, 3
  s_lshl_b32 s36, s36, 6
  s_add_u32 s7, s7, s36
  s_lshr_b32 s36, s6, 2
  s_lshl_b32 s36, s36, 18
  s_add_u32 s7, s7, s36
  s_add_u32 s46, s7, 0x40000
  s_lshl_b32 s36, s68, 15
  s_add_u32 s45, s7, s36
  s_and_b32 s7, s38, 3
  s_lshl_b32 s7, s7, 3
  s_and_b32 s36, s6, 3
  s_lshl_b32 s36, s36, 1
  s_add_u32 s7, s7, s36
  s_lshr_b32 s36, s6, 2
  s_add_u32 s7, s7, s36
  s_lshl_b32 s36, s37, 3
  s_add_u32 s36, s36, s68
  s_lshl_b32 s36, s36, 15
  s_lshl_b32 s64, s7, 5
  s_add_u32 s64, s64, s36
  s_lshl_b32 s55, s7, 10
  s_add_u32 s55, s55, s36
  s_add_u32 s55, s55, 0x800000
  s_lshl_b32 s54, s39, 15
  s_lshl_b32 s7, s65, 10
  s_add_u32 s54, s54, s7
  s_add_u32 s54, s54, 0x600000
  s_lshl_b32 s7, s37, 2
  s_add_u32 s7, s7, s66
  s_lshl_b32 s61, s7, 8
  s_add_u32 s61, s61, 0xb04000
  s_lshl_b32 s75, s7, 16
  s_mul_i32 s74, s7, 0x38000
  s_add_u32 s74, s74, 0xc00000
  s_mul_i32 s7, s67, 0x3800
  s_lshl_b32 s36, s6, 11
  s_add_u32 s7, s7, s36
  s_add_u32 s7, s7, s74
  s_lshr_b32 s36, s6, 2
  s_lshl_b32 s36, s36, 10
  s_add_u32 s56, s7, s36
  s_xor_b32 s57, s56, 0x400
  s_mul_i32 s36, s6, 0x3800
  s_add_u32 s74, s74, s36
  s_lshl_b32 s36, s67, 5
  s_add_u32 s60, s61, s36
  s_lshl_b32 s36, s6, 2
  s_add_u32 s60, s60, s36
  s_lshl_b32 s36, s6, 5
  s_add_u32 s62, s61, s36
  s_add_u32 s62, s62, 0x4000
  s_lshl_b32 s58, s39, 10
  s_lshl_b32 s36, s37, 7
  s_add_u32 s58, s58, s36
  s_and_b32 s36, s38, 3
  s_lshl_b32 s36, s36, 2
  s_add_u32 s58, s58, s36
  s_add_u32 s58, s58, 0xb10000
  s_lshl_b32 s59, s37, 3
  s_add_u32 s59, s59, s68
  s_lshl_b32 s59, s59, 10
  s_add_u32 s59, s59, 0xb10000
  s_lshl_b32 s63, s37, 7
  s_add_u32 s63, s63, 0xb00000
  s_lshl_b32 s65, s38, 3
  s_add_u32 s65, s65, s6
  s_mul_i32 s65, s65, 0x1c00
  v_lshrrev_b32 v16, 4, v1
  v_mov_b32 v17, s55
  s_and_b32 s7, s56, 0xfffffbff
  s_sub_u32 s36, s55, 0x400
  v_mov_b32 v18, s36
  v_cmp_gt_u32 vcc, 8, v16
  s_nop 1
  v_cndmask_b32 v17, v18, v17, vcc
  s_sub_u32 s36, s7, 0x800
  v_mov_b32 v18, s36
  v_cmp_gt_u32 vcc, 16, v16
  s_nop 1
  v_cndmask_b32 v17, v18, v17, vcc
  s_add_u32 s36, s7, 0x1b000
  v_mov_b32 v18, s36
  v_cmp_gt_u32 vcc, 32, v16
  s_nop 1
  v_cndmask_b32 v17, v18, v17, vcc
  s_sub_u32 s36, s60, 0x1800
  v_mov_b32 v18, s36
  v_cmp_gt_u32 vcc, 48, v16
  s_nop 1
  v_cndmask_b32 v17, v18, v17, vcc
  s_sub_u32 s36, s60, 0x1880
  v_mov_b32 v18, s36
  v_cmp_gt_u32 vcc, 49, v16
  s_nop 1
  v_cndmask_b32 v17, v18, v17, vcc
  s_add_u32 s36, s60, 0x2700
  v_mov_b32 v18, s36
  v_cmp_gt_u32 vcc, 50, v16
  s_nop 1
  v_cndmask_b32 v17, v18, v17, vcc
  s_add_u32 s36, s60, 0x6680
  v_mov_b32 v18, s36
  v_cmp_gt_u32 vcc, 51, v16
  s_nop 1
  v_cndmask_b32 v17, v18, v17, vcc
  v_min_u32 v18, 51, v16
  v_lshl_add_u32 v11, v18, 7, v17
  s_mul_i32 s7, s67, 0x1c0
  s_lshl_b32 s36, s6, 6
  s_add_u32 s7, s7, s36
  s_add_u32 s48, s7, 0x1c0000
  s_mul_i32 s36, s66, 0x70000
  s_add_u32 s47, s7, s36
  s_mov_b32 s49, 0xe000
  s_mov_b32 s50, 0xe000
  s_lshl_b32 s7, s67, 7
  s_mul_i32 s69, s6, 0x38000
  s_add_u32 s69, s69, s7
  s_add_u32 s75, s75, s7
  v_lshrrev_b32 v18, 2, v16
  v_and_b32 v253, 48, v1
  v_lshl_add_u32 v9, v18, 10, v253
  v_mul_u32_u24 v18, 0xe00, v18
  v_add_u32 v8, v18, v253
  s_cmp_lg_u32 s6, 7
  s_cbranch_scc1 k6_kernel_n75
  s_load_dwordx2 s[16:17], s[0:1], 40
  s_mov_b32 s18, 0x1c0000
  s_mov_b32 s47, s69
  s_mov_b32 s48, -1
  s_mov_b32 s49, 0x3fc0
  s_mov_b32 s50, 64
  v_mov_b32 v8, v9
k6_kernel_n75:
  v_lshrrev_b32 v18, 5, v16
  v_bfe_u32 v253, v16, 2, 2
  v_lshl_add_u32 v253, v18, 2, v253
  v_lshlrev_b32 v253, 6, v253
  v_bfe_u32 v254, v16, 4, 1
  s_lshr_b32 s7, s6, 2
  v_xor_b32 v254, s7, v254
  v_lshl_add_u32 v253, v254, 5, v253
  v_and_b32 v254, 3, v16
  v_lshl_add_u32 v253, v254, 3, v253
  v_add_u32 v10, s44, v253
  v_and_b32 v255, 31, v16
  v_lshlrev_b32 v255, 2, v255
  v_lshrrev_b32 v253, 3, v0
  v_min_u32 v253, 39, v253
  v_mul_u32_u24 v253, 0x820, v253
  v_and_b32 v254, 7, v0
  v_lshl_add_u32 v253, v254, 2, v253
  v_cmp_gt_u32 vcc, 4, v254
  v_mov_b32 v254, 0x3f803f80
  s_nop 0
  v_cndmask_b32 v254, 0, v254, vcc
  v_mov_b32 v20, v253
  v_mov_b32 v21, v254
  v_and_b32 v253, 0x1f0, v1
  v_and_b32 v254, 0x200, v1
  v_lshrrev_b32 v254, 1, v254
  v_or_b32 v254, 0x400, v254
  v_add_u32 v254, v253, v254
  v_and_b32 v6, 0xb0, v253
  v_cmp_eq_u32 vcc, 0, v6
  v_mov_b32 v6, 0x810
  v_mov_b32 v7, 0x800
  v_cndmask_b32 v6, v6, v7, vcc
  v_cmp_gt_u32 vcc, 0x100, v253
  v_mov_b32 v253, v6
  s_nop 0
  v_cndmask_b32 v4, v253, v254, vcc
  v_add_u32 v254, 0x200, v254
  v_cndmask_b32 v5, v253, v254, vcc
  v_add_u32 v6, 0x10400, v4
  v_add_u32 v7, 0x10400, v5
  v_add_u32 v3, 0x10400, v1
  v_mov_b32 v2, 0xdddddddd
  v_mov_b32 v252, s53
  v_mov_b32 v60, 0
  v_mov_b32 v61, 0
  v_mov_b32 v62, 0
  v_mov_b32 v63, 0
  v_mov_b32 v64, 0
  v_mov_b32 v65, 0
  v_mov_b32 v66, 0
  v_mov_b32 v67, 0
  v_mov_b32 v68, 0
  v_mov_b32 v69, 0
  v_mov_b32 v70, 0
  v_mov_b32 v71, 0
  v_mov_b32 v72, 0
  v_mov_b32 v73, 0
  v_mov_b32 v74, 0
  v_mov_b32 v75, 0
  v_mov_b32 v22, s3
  v_mov_b32 v23, 1
  s_lshl_b32 s7, s37, 5
  s_and_b32 s36, s38, 2
  s_lshl_b32 s36, s36, 3
  s_add_u32 s7, s7, s36
  v_and_b32 v24, 12, v255
  v_add_u32 v24, s7, v24
  s_mov_b32 s7, 0x1010101
  s_waitcnt lgkmcnt(0)
  s_cmp_eq_u32 s6, 5
  s_cbranch_scc1 k6_kernel_hp6
k6_kernel_np7:
  s_add_u32 s42, s41, 0x1ffc00
  s_barrier
  s_mov_b32 m0, s43
  s_nop 0
  buffer_load_dwordx4 v1, s[8:11], s41 offen lds
  buffer_load_dwordx4 v[12:15], v1, s[8:11], s70 offen
  buffer_load_dwordx4 v1, s[8:11], s42 offen offset:1024 lds
  s_add_u32 m0, s43, 0x4100
  s_add_u32 s76, s76, 0x2000
  s_and_b32 s76, s76, 0xffff
  s_add_u32 s41, s40, s76
  buffer_load_dwordx4 v1, s[8:11], s41 offen lds
  s_add_u32 m0, s43, 0x4100
  s_add_u32 s42, s41, 0x1ffc00
  buffer_load_dwordx4 v1, s[8:11], s42 offen offset:1024 lds
  ds_write_b32 v20, v21 offset:2048
  s_cmp_eq_u32 s6, 4
  s_cselect_b64 exec, 1, 0
  global_store_byte v22, v23, s[4:5] sc1
  s_mov_b64 exec, -1
  s_waitcnt vmcnt(2) lgkmcnt(0)
  s_barrier
  ds_read_b128 v[16:19], v1 offset:0
  ds_read_b128 v[44:47], v1 offset:2080
  ds_read_b128 v[20:23], v4 offset:0
  ds_read_b128 v[24:27], v5 offset:0
  s_waitcnt lgkmcnt(3)
  v_mfma_f32_32x32x16_bf16 v[28:43], v[16:19], v[12:15], 0
  s_waitcnt lgkmcnt(2)
  v_mov_b32 v16, v44
  v_mov_b32 v17, v45
  v_mov_b32 v18, v46
  v_mov_b32 v19, v47
  s_nop 6
  v_max3_f32 v0, v28, v29, v30
  v_max_f32 v0, v0, v31
  v_max3_f32 v0, v0, v32, v33
  v_max3_f32 v0, v0, v34, v35
  v_max3_f32 v0, v0, v36, v37
  v_max3_f32 v0, v0, v38, v39
  v_max3_f32 v0, v0, v40, v41
  v_max3_f32 v0, v0, v42, v43
  v_mov_b32 v253, v0
  s_nop 1
  v_permlane32_swap_b32 v0, v253
  v_max_f32 v0, v0, v253
  v_sub_f32 v28, v28, v0
  v_sub_f32 v29, v29, v0
  v_sub_f32 v30, v30, v0
  v_sub_f32 v31, v31, v0
  v_sub_f32 v32, v32, v0
  v_sub_f32 v33, v33, v0
  v_sub_f32 v34, v34, v0
  v_sub_f32 v35, v35, v0
  v_sub_f32 v36, v36, v0
  v_sub_f32 v37, v37, v0
  v_sub_f32 v38, v38, v0
  v_sub_f32 v39, v39, v0
  v_sub_f32 v40, v40, v0
  v_sub_f32 v41, v41, v0
  v_sub_f32 v42, v42, v0
  v_sub_f32 v43, v43, v0
  v_exp_f32 v28, v28
  v_exp_f32 v29, v29
  v_sub_f32 v76, 0, v0
  v_sub_f32 v77, 0, v0
  v_sub_f32 v78, 0, v0
  v_sub_f32 v79, 0, v0
  v_sub_f32 v80, 0, v0
  v_sub_f32 v81, 0, v0
  v_sub_f32 v82, 0, v0
  v_sub_f32 v83, 0, v0
  v_sub_f32 v84, 0, v0
  v_sub_f32 v85, 0, v0
  v_sub_f32 v86, 0, v0
  v_sub_f32 v87, 0, v0
  v_sub_f32 v88, 0, v0
  v_sub_f32 v89, 0, v0
  v_sub_f32 v90, 0, v0
  v_sub_f32 v91, 0, v0
  v_exp_f32 v30, v30
  v_exp_f32 v31, v31
  v_exp_f32 v32, v32
  v_exp_f32 v33, v33
  v_exp_f32 v34, v34
  v_mfma_f32_32x32x16_bf16 v[44:59], v[16:19], v[12:15], v[76:91]
  ds_read_b128 v[16:19], v1 offset:4160
  v_exp_f32 v35, v35
  v_exp_f32 v36, v36
  v_exp_f32 v37, v37
  v_exp_f32 v38, v38
  v_exp_f32 v39, v39
  s_waitcnt lgkmcnt(2)
  v_smfmac_f32_32x32x32_bf16 v[60:75], v[20:23], v[28:35], v2
  ds_read_b128 v[20:23], v4 offset:2080
  v_exp_f32 v40, v40
  v_exp_f32 v41, v41
  v_exp_f32 v42, v42
  v_exp_f32 v43, v43
  v_exp_f32 v44, v44
  v_exp_f32 v45, v45
  s_waitcnt lgkmcnt(2)
  v_smfmac_f32_32x32x32_bf16 v[60:75], v[24:27], v[36:43], v2
  ds_read_b128 v[24:27], v5 offset:2080
  v_exp_f32 v46, v46
  v_exp_f32 v47, v47
  v_exp_f32 v48, v48
  v_exp_f32 v49, v49
  v_exp_f32 v50, v50
  s_waitcnt lgkmcnt(2)
  v_mfma_f32_32x32x16_bf16 v[28:43], v[16:19], v[12:15], v[76:91]
  ds_read_b128 v[16:19], v1 offset:6240
  s_add_u32 m0, s43, 0x8200
  s_add_u32 s76, s76, 0x2000
  s_and_b32 s76, s76, 0xffff
  s_add_u32 s41, s40, s76
  buffer_load_dwordx4 v1, s[8:11], s41 offen lds
  v_exp_f32 v51, v51
  v_exp_f32 v52, v52
  v_exp_f32 v53, v53
  v_exp_f32 v54, v54
  v_exp_f32 v55, v55
  s_waitcnt lgkmcnt(2)
  v_smfmac_f32_32x32x32_bf16 v[60:75], v[20:23], v[44:51], v2
  ds_read_b128 v[20:23], v4 offset:4160
  v_exp_f32 v56, v56
  v_exp_f32 v57, v57
  v_exp_f32 v58, v58
  v_exp_f32 v59, v59
  v_exp_f32 v28, v28
  v_exp_f32 v29, v29
  s_waitcnt lgkmcnt(2)
  v_smfmac_f32_32x32x32_bf16 v[60:75], v[24:27], v[52:59], v2
  ds_read_b128 v[24:27], v5 offset:4160
  v_exp_f32 v30, v30
  v_exp_f32 v31, v31
  v_exp_f32 v32, v32
  v_exp_f32 v33, v33
  v_exp_f32 v34, v34
  s_waitcnt lgkmcnt(2)
  v_mfma_f32_32x32x16_bf16 v[44:59], v[16:19], v[12:15], v[76:91]
  ds_read_b128 v[16:19], v1 offset:8320
  v_exp_f32 v35, v35
  v_exp_f32 v36, v36
  v_exp_f32 v37, v37
  v_exp_f32 v38, v38
  v_exp_f32 v39, v39
  s_waitcnt lgkmcnt(2)
  v_smfmac_f32_32x32x32_bf16 v[60:75], v[20:23], v[28:35], v2
  ds_read_b128 v[20:23], v4 offset:6240
  v_exp_f32 v40, v40
  v_exp_f32 v41, v41
  s_add_u32 m0, s44, 0
  s_nop 0
  buffer_load_dwordx4 v9, s[12:15], s45 offen lds
  v_exp_f32 v42, v42
  v_exp_f32 v43, v43
  v_exp_f32 v44, v44
  v_exp_f32 v45, v45
  s_waitcnt lgkmcnt(2)
  v_smfmac_f32_32x32x32_bf16 v[60:75], v[24:27], v[36:43], v2
  ds_read_b128 v[24:27], v5 offset:6240
  v_exp_f32 v46, v46
  v_exp_f32 v47, v47
  v_exp_f32 v48, v48
  v_exp_f32 v49, v49
  v_exp_f32 v50, v50
  s_waitcnt lgkmcnt(2)
  v_mfma_f32_32x32x16_bf16 v[28:43], v[16:19], v[12:15], v[76:91]
  ds_read_b128 v[16:19], v1 offset:10400
  s_add_u32 m0, s43, 0x8200
  s_add_u32 s42, s41, 0x1ffc00
  buffer_load_dwordx4 v1, s[8:11], s42 offen offset:1024 lds
  v_exp_f32 v51, v51
  v_exp_f32 v52, v52
  v_exp_f32 v53, v53
  v_exp_f32 v54, v54
  v_exp_f32 v55, v55
  s_waitcnt lgkmcnt(2)
  v_smfmac_f32_32x32x32_bf16 v[60:75], v[20:23], v[44:51], v2
  ds_read_b128 v[20:23], v4 offset:8320
  v_exp_f32 v56, v56
  v_exp_f32 v57, v57
  s_add_u32 m0, s44, 0x400
  s_add_u32 s45, s45, 0x4000
  buffer_load_dwordx4 v9, s[12:15], s45 offen lds
  v_exp_f32 v58, v58
  v_exp_f32 v59, v59
  v_exp_f32 v28, v28
  v_exp_f32 v29, v29
  s_waitcnt lgkmcnt(2)
  v_smfmac_f32_32x32x32_bf16 v[60:75], v[24:27], v[52:59], v2
  ds_read_b128 v[24:27], v5 offset:8320
  v_exp_f32 v30, v30
  v_exp_f32 v31, v31
  v_exp_f32 v32, v32
  v_exp_f32 v33, v33
  v_exp_f32 v34, v34
  s_waitcnt lgkmcnt(2)
  v_mfma_f32_32x32x16_bf16 v[44:59], v[16:19], v[12:15], v[76:91]
  ds_read_b128 v[16:19], v1 offset:12480
  v_exp_f32 v35, v35
  v_exp_f32 v36, v36
  v_exp_f32 v37, v37
  v_exp_f32 v38, v38
  v_exp_f32 v39, v39
  s_waitcnt lgkmcnt(2)
  v_smfmac_f32_32x32x32_bf16 v[60:75], v[20:23], v[28:35], v2
  ds_read_b128 v[20:23], v4 offset:10400
  v_exp_f32 v40, v40
  v_exp_f32 v41, v41
  s_add_u32 m0, s44, 0x800
  s_add_u32 s45, s45, 0x4000
  s_cmp_ge_u32 s45, s46
  s_cselect_b32 s7, 0x40000, 0
  s_sub_u32 s45, s45, s7
  buffer_load_dwordx4 v9, s[12:15], s45 offen lds
  v_exp_f32 v42, v42
  v_exp_f32 v43, v43
  v_exp_f32 v44, v44
  v_exp_f32 v45, v45
  s_waitcnt lgkmcnt(2)
  v_smfmac_f32_32x32x32_bf16 v[60:75], v[24:27], v[36:43], v2
  ds_read_b128 v[24:27], v5 offset:10400
  v_exp_f32 v46, v46
  v_exp_f32 v47, v47
  v_exp_f32 v48, v48
  v_exp_f32 v49, v49
  v_exp_f32 v50, v50
  s_waitcnt lgkmcnt(2)
  v_mfma_f32_32x32x16_bf16 v[28:43], v[16:19], v[12:15], v[76:91]
  ds_read_b128 v[16:19], v1 offset:14560
  v_exp_f32 v51, v51
  v_exp_f32 v52, v52
  v_exp_f32 v53, v53
  v_exp_f32 v54, v54
  v_exp_f32 v55, v55
  s_waitcnt lgkmcnt(2)
  v_smfmac_f32_32x32x32_bf16 v[60:75], v[20:23], v[44:51], v2
  ds_read_b128 v[20:23], v4 offset:12480
  v_exp_f32 v56, v56
  v_exp_f32 v57, v57
  s_add_u32 m0, s44, 0xc00
  s_add_u32 s45, s45, 0x4000
  buffer_load_dwordx4 v9, s[12:15], s45 offen lds
  v_exp_f32 v58, v58
  v_exp_f32 v59, v59
  v_exp_f32 v28, v28
  v_exp_f32 v29, v29
  s_waitcnt lgkmcnt(2)
  v_smfmac_f32_32x32x32_bf16 v[60:75], v[24:27], v[52:59], v2
  ds_read_b128 v[24:27], v5 offset:12480
  v_exp_f32 v30, v30
  v_exp_f32 v31, v31
  v_exp_f32 v32, v32
  v_exp_f32 v33, v33
  v_exp_f32 v34, v34
  s_waitcnt lgkmcnt(2)
  v_mfma_f32_32x32x16_bf16 v[44:59], v[16:19], v[12:15], v[76:91]
  s_waitcnt vmcnt(6)
  s_barrier
  ds_read_b128 v[16:19], v1 offset:16640
  v_exp_f32 v35, v35
  v_exp_f32 v36, v36
  v_exp_f32 v37, v37
  v_exp_f32 v38, v38
  v_exp_f32 v39, v39
  s_waitcnt lgkmcnt(2)
  v_smfmac_f32_32x32x32_bf16 v[60:75], v[20:23], v[28:35], v2
  ds_read_b128 v[20:23], v4 offset:14560
  v_exp_f32 v40, v40
  v_exp_f32 v41, v41
  s_add_u32 m0, s44, 0x1000
  s_add_u32 s45, s45, 0x4000
  s_cmp_ge_u32 s45, s46
  s_cselect_b32 s7, 0x40000, 0
  s_sub_u32 s45, s45, s7
  buffer_load_dwordx4 v9, s[12:15], s45 offen lds
  v_exp_f32 v42, v42
  v_exp_f32 v43, v43
  v_exp_f32 v44, v44
  v_exp_f32 v45, v45
  s_waitcnt lgkmcnt(2)
  v_smfmac_f32_32x32x32_bf16 v[60:75], v[24:27], v[36:43], v2
  ds_read_b128 v[24:27], v5 offset:14560
  v_exp_f32 v46, v46
  v_exp_f32 v47, v47
  v_exp_f32 v48, v48
  v_exp_f32 v49, v49
  v_exp_f32 v50, v50
  s_waitcnt lgkmcnt(2)
  v_mfma_f32_32x32x16_bf16 v[28:43], v[16:19], v[12:15], v[76:91]
  ds_read_b128 v[16:19], v1 offset:18720
  s_add_u32 m0, s43, 0xc300
  s_add_u32 s76, s76, 0x2000
  s_and_b32 s76, s76, 0xffff
  s_add_u32 s41, s40, s76
  buffer_load_dwordx4 v1, s[8:11], s41 offen lds
  v_exp_f32 v51, v51
  v_exp_f32 v52, v52
  v_exp_f32 v53, v53
  v_exp_f32 v54, v54
  v_exp_f32 v55, v55
  s_waitcnt lgkmcnt(2)
  v_smfmac_f32_32x32x32_bf16 v[60:75], v[20:23], v[44:51], v2
  ds_read_b128 v[20:23], v4 offset:16640
  v_exp_f32 v56, v56
  v_exp_f32 v57, v57
  s_add_u32 m0, s44, 0x1400
  s_add_u32 s45, s45, 0x4000
  buffer_load_dwordx4 v9, s[12:15], s45 offen lds
  v_exp_f32 v58, v58
  v_exp_f32 v59, v59
  v_exp_f32 v28, v28
  v_exp_f32 v29, v29
  s_waitcnt lgkmcnt(2)
  v_smfmac_f32_32x32x32_bf16 v[60:75], v[24:27], v[52:59], v2
  ds_read_b128 v[24:27], v5 offset:16640
  v_exp_f32 v30, v30
  v_exp_f32 v31, v31
  v_exp_f32 v32, v32
  v_exp_f32 v33, v33
  v_exp_f32 v34, v34
  s_waitcnt lgkmcnt(2)
  v_mfma_f32_32x32x16_bf16 v[44:59], v[16:19], v[12:15], v[76:91]
  ds_read_b128 v[16:19], v1 offset:20800
  v_exp_f32 v35, v35
  v_exp_f32 v36, v36
  v_exp_f32 v37, v37
  v_exp_f32 v38, v38
  v_exp_f32 v39, v39
  s_waitcnt lgkmcnt(2)
  v_smfmac_f32_32x32x32_bf16 v[60:75], v[20:23], v[28:35], v2
  ds_read_b128 v[20:23], v4 offset:18720
  v_exp_f32 v40, v40
  v_exp_f32 v41, v41
  s_add_u32 m0, s44, 0x1800
  s_add_u32 s45, s45, 0x4000
  s_cmp_ge_u32 s45, s46
  s_cselect_b32 s7, 0x40000, 0
  s_sub_u32 s45, s45, s7
  buffer_load_dwordx4 v9, s[12:15], s45 offen lds
  v_exp_f32 v42, v42
  v_exp_f32 v43, v43
  v_exp_f32 v44, v44
  v_exp_f32 v45, v45
  s_waitcnt lgkmcnt(2)
  v_smfmac_f32_32x32x32_bf16 v[60:75], v[24:27], v[36:43], v2
  ds_read_b128 v[24:27], v5 offset:18720
  v_exp_f32 v46, v46
  v_exp_f32 v47, v47
  v_exp_f32 v48, v48
  v_exp_f32 v49, v49
  v_exp_f32 v50, v50
  s_waitcnt lgkmcnt(2)
  v_mfma_f32_32x32x16_bf16 v[28:43], v[16:19], v[12:15], v[76:91]
  ds_read_b128 v[16:19], v1 offset:22880
  s_add_u32 m0, s43, 0xc300
  s_add_u32 s42, s41, 0x1ffc00
  buffer_load_dwordx4 v1, s[8:11], s42 offen offset:1024 lds
  v_exp_f32 v51, v51
  v_exp_f32 v52, v52
  v_exp_f32 v53, v53
  v_exp_f32 v54, v54
  v_exp_f32 v55, v55
  s_waitcnt lgkmcnt(2)
  v_smfmac_f32_32x32x32_bf16 v[60:75], v[20:23], v[44:51], v2
  ds_read_b128 v[20:23], v4 offset:20800
  s_waitcnt vmcnt(9)
  ds_read_b64_tr_b16 v[92:93], v10 offset:0
  ds_read_b64_tr_b16 v[94:95], v10 offset:512
  v_exp_f32 v56, v56
  v_exp_f32 v57, v57
  s_add_u32 m0, s44, 0x1c00
  s_add_u32 s45, s45, 0x4000
  buffer_load_dwordx4 v9, s[12:15], s45 offen lds
  v_exp_f32 v58, v58
  v_exp_f32 v59, v59
  v_exp_f32 v28, v28
  v_exp_f32 v29, v29
  s_waitcnt lgkmcnt(4)
  v_smfmac_f32_32x32x32_bf16 v[60:75], v[24:27], v[52:59], v2
  ds_read_b128 v[24:27], v5 offset:20800
  v_exp_f32 v30, v30
  v_exp_f32 v31, v31
  v_exp_f32 v32, v32
  v_exp_f32 v33, v33
  v_exp_f32 v34, v34
  s_waitcnt lgkmcnt(4)
  v_mfma_f32_32x32x16_bf16 v[44:59], v[16:19], v[12:15], v[76:91]
  ds_read_b128 v[16:19], v1 offset:24960
  v_exp_f32 v35, v35
  v_exp_f32 v36, v36
  v_exp_f32 v37, v37
  v_exp_f32 v38, v38
  v_exp_f32 v39, v39
  s_waitcnt lgkmcnt(4)
  v_smfmac_f32_32x32x32_bf16 v[60:75], v[20:23], v[28:35], v2
  ds_read_b128 v[20:23], v4 offset:22880
  s_waitcnt vmcnt(8)
  ds_read_b64_tr_b16 v[96:97], v10 offset:1024
  ds_read_b64_tr_b16 v[98:99], v10 offset:1536
  v_exp_f32 v40, v40
  v_exp_f32 v41, v41
  s_add_u32 m0, s44, 0
  s_nop 0
  buffer_load_dwordx4 v8, s[16:19], s47 offen lds
  v_exp_f32 v42, v42
  v_exp_f32 v43, v43
  v_exp_f32 v44, v44
  v_exp_f32 v45, v45
  s_waitcnt lgkmcnt(4)
  v_smfmac_f32_32x32x32_bf16 v[60:75], v[24:27], v[36:43], v2
  ds_read_b128 v[24:27], v5 offset:22880
  v_exp_f32 v46, v46
  v_exp_f32 v47, v47
  v_exp_f32 v48, v48
  v_exp_f32 v49, v49
  v_exp_f32 v50, v50
  s_waitcnt lgkmcnt(4)
  v_mfma_f32_32x32x16_bf16 v[28:43], v[16:19], v[12:15], v[76:91]
  ds_read_b128 v[16:19], v1 offset:27040
  v_lshrrev_b32 v254, 2, v1
  s_cmp_eq_u32 s6, 0
  s_cselect_b64 exec, -1, 0
  global_load_dword v252, v254, s[4:5] sc1
  s_mov_b64 exec, -1
  v_exp_f32 v51, v51
  v_exp_f32 v52, v52
  v_exp_f32 v53, v53
  v_exp_f32 v54, v54
  v_exp_f32 v55, v55
  s_waitcnt lgkmcnt(4)
  v_smfmac_f32_32x32x32_bf16 v[60:75], v[20:23], v[44:51], v2
  ds_read_b128 v[20:23], v4 offset:24960
  s_waitcnt vmcnt(8)
  ds_read_b64_tr_b16 v[100:101], v10 offset:2048
  ds_read_b64_tr_b16 v[102:103], v10 offset:2560
  v_exp_f32 v56, v56
  v_exp_f32 v57, v57
  s_add_u32 m0, s44, 0x400
  s_add_u32 s47, s47, s50
  buffer_load_dwordx4 v8, s[16:19], s47 offen lds
  v_exp_f32 v58, v58
  v_exp_f32 v59, v59
  v_exp_f32 v28, v28
  v_exp_f32 v29, v29
  s_waitcnt lgkmcnt(4)
  v_smfmac_f32_32x32x32_bf16 v[60:75], v[24:27], v[52:59], v2
  ds_read_b128 v[24:27], v5 offset:24960
  v_exp_f32 v30, v30
  v_exp_f32 v31, v31
  v_exp_f32 v32, v32
  v_exp_f32 v33, v33
  v_exp_f32 v34, v34
  s_waitcnt lgkmcnt(4)
  v_mfma_f32_32x32x16_bf16 v[44:59], v[16:19], v[12:15], v[76:91]
  ds_read_b128 v[16:19], v1 offset:29120
  v_exp_f32 v35, v35
  v_exp_f32 v36, v36
  v_exp_f32 v37, v37
  v_exp_f32 v38, v38
  v_exp_f32 v39, v39
  s_waitcnt lgkmcnt(4)
  v_smfmac_f32_32x32x32_bf16 v[60:75], v[20:23], v[28:35], v2
  ds_read_b128 v[20:23], v4 offset:27040
  s_waitcnt vmcnt(8)
  ds_read_b64_tr_b16 v[104:105], v10 offset:3072
  ds_read_b64_tr_b16 v[106:107], v10 offset:3584
  v_exp_f32 v40, v40
  v_exp_f32 v41, v41
  s_add_u32 m0, s44, 0x800
  s_add_u32 s47, s47, s49
  buffer_load_dwordx4 v8, s[16:19], s47 offen lds
  v_exp_f32 v42, v42
  v_exp_f32 v43, v43
  v_exp_f32 v44, v44
  v_exp_f32 v45, v45
  s_waitcnt lgkmcnt(4)
  v_smfmac_f32_32x32x32_bf16 v[60:75], v[24:27], v[36:43], v2
  ds_read_b128 v[24:27], v5 offset:27040
  v_exp_f32 v46, v46
  v_exp_f32 v47, v47
  v_exp_f32 v48, v48
  v_exp_f32 v49, v49
  v_exp_f32 v50, v50
  s_waitcnt lgkmcnt(4)
  v_mfma_f32_32x32x16_bf16 v[28:43], v[16:19], v[12:15], v[76:91]
  ds_read_b128 v[16:19], v1 offset:31200
  v_exp_f32 v51, v51
  v_exp_f32 v52, v52
  v_exp_f32 v53, v53
  v_exp_f32 v54, v54
  v_exp_f32 v55, v55
  s_waitcnt lgkmcnt(4)
  v_smfmac_f32_32x32x32_bf16 v[60:75], v[20:23], v[44:51], v2
  ds_read_b128 v[20:23], v4 offset:29120
  s_waitcnt vmcnt(8)
  ds_read_b64_tr_b16 v[108:109], v10 offset:4096
  ds_read_b64_tr_b16 v[110:111], v10 offset:4608
  v_exp_f32 v56, v56
  v_exp_f32 v57, v57
  s_add_u32 m0, s44, 0xc00
  s_add_u32 s47, s47, s50
  buffer_load_dwordx4 v8, s[16:19], s47 offen lds
  v_exp_f32 v58, v58
  v_exp_f32 v59, v59
  v_exp_f32 v28, v28
  v_exp_f32 v29, v29
  s_waitcnt lgkmcnt(4)
  v_smfmac_f32_32x32x32_bf16 v[60:75], v[24:27], v[52:59], v2
  ds_read_b128 v[24:27], v5 offset:29120
  v_exp_f32 v30, v30
  v_exp_f32 v31, v31
  v_exp_f32 v32, v32
  v_exp_f32 v33, v33
  v_exp_f32 v34, v34
  s_waitcnt lgkmcnt(4)
  v_mfma_f32_32x32x16_bf16 v[44:59], v[16:19], v[12:15], v[76:91]
  s_barrier
  ds_read_b128 v[16:19], v1 offset:33280
  v_exp_f32 v35, v35
  v_exp_f32 v36, v36
  v_exp_f32 v37, v37
  v_exp_f32 v38, v38
  v_exp_f32 v39, v39
  s_waitcnt lgkmcnt(4)
  v_smfmac_f32_32x32x32_bf16 v[60:75], v[20:23], v[28:35], v2
  ds_read_b128 v[20:23], v4 offset:31200
  s_waitcnt vmcnt(7)
  ds_read_b64_tr_b16 v[112:113], v10 offset:5120
  ds_read_b64_tr_b16 v[114:115], v10 offset:5632
  v_exp_f32 v40, v40
  v_exp_f32 v41, v41
  s_add_u32 m0, s44, 0x1000
  s_add_u32 s47, s47, s49
  buffer_load_dwordx4 v8, s[16:19], s47 offen lds
  v_exp_f32 v42, v42
  v_exp_f32 v43, v43
  v_exp_f32 v44, v44
  v_exp_f32 v45, v45
  s_waitcnt lgkmcnt(4)
  v_smfmac_f32_32x32x32_bf16 v[60:75], v[24:27], v[36:43], v2
  ds_read_b128 v[24:27], v5 offset:31200
  v_exp_f32 v46, v46
  v_exp_f32 v47, v47
  v_exp_f32 v48, v48
  v_exp_f32 v49, v49
  v_exp_f32 v50, v50
  s_waitcnt lgkmcnt(4)
  v_mfma_f32_32x32x16_bf16 v[28:43], v[16:19], v[12:15], v[76:91]
  ds_read_b128 v[16:19], v1 offset:35360
  s_add_u32 m0, s43, 0
  s_add_u32 s76, s76, 0x2000
  s_and_b32 s76, s76, 0xffff
  s_add_u32 s41, s40, s76
  buffer_load_dwordx4 v1, s[8:11], s41 offen lds
  v_exp_f32 v51, v51
  v_exp_f32 v52, v52
  v_exp_f32 v53, v53
  v_exp_f32 v54, v54
  v_exp_f32 v55, v55
  s_waitcnt lgkmcnt(4)
  v_smfmac_f32_32x32x32_bf16 v[60:75], v[20:23], v[44:51], v2
  ds_read_b128 v[20:23], v4 offset:33280
  s_waitcnt vmcnt(8)
  ds_read_b64_tr_b16 v[116:117], v10 offset:6144
  ds_read_b64_tr_b16 v[118:119], v10 offset:6656
  v_exp_f32 v56, v56
  v_exp_f32 v57, v57
  s_add_u32 m0, s44, 0x1400
  s_add_u32 s47, s47, s50
  buffer_load_dwordx4 v8, s[16:19], s47 offen lds
  v_exp_f32 v58, v58
  v_exp_f32 v59, v59
  v_exp_f32 v28, v28
  v_exp_f32 v29, v29
  s_waitcnt lgkmcnt(4)
  v_smfmac_f32_32x32x32_bf16 v[60:75], v[24:27], v[52:59], v2
  ds_read_b128 v[24:27], v5 offset:33280
  v_exp_f32 v30, v30
  v_exp_f32 v31, v31
  v_exp_f32 v32, v32
  v_exp_f32 v33, v33
  v_exp_f32 v34, v34
  s_waitcnt lgkmcnt(4)
  v_mfma_f32_32x32x16_bf16 v[44:59], v[16:19], v[12:15], v[76:91]
  ds_read_b128 v[16:19], v1 offset:37440
  v_exp_f32 v35, v35
  v_exp_f32 v36, v36
  v_exp_f32 v37, v37
  v_exp_f32 v38, v38
  v_exp_f32 v39, v39
  s_waitcnt lgkmcnt(4)
  v_smfmac_f32_32x32x32_bf16 v[60:75], v[20:23], v[28:35], v2
  ds_read_b128 v[20:23], v4 offset:35360
  s_waitcnt vmcnt(7)
  ds_read_b64_tr_b16 v[120:121], v10 offset:7168
  ds_read_b64_tr_b16 v[122:123], v10 offset:7680
  v_exp_f32 v40, v40
  v_exp_f32 v41, v41
  s_add_u32 m0, s44, 0x1800
  s_add_u32 s47, s47, s49
  buffer_load_dwordx4 v8, s[16:19], s47 offen lds
  v_exp_f32 v42, v42
  v_exp_f32 v43, v43
  v_exp_f32 v44, v44
  v_exp_f32 v45, v45
  s_waitcnt lgkmcnt(4)
  v_smfmac_f32_32x32x32_bf16 v[60:75], v[24:27], v[36:43], v2
  ds_read_b128 v[24:27], v5 offset:35360
  v_exp_f32 v46, v46
  v_exp_f32 v47, v47
  v_exp_f32 v48, v48
  v_exp_f32 v49, v49
  v_exp_f32 v50, v50
  s_waitcnt lgkmcnt(4)
  v_mfma_f32_32x32x16_bf16 v[28:43], v[16:19], v[12:15], v[76:91]
  ds_read_b128 v[16:19], v1 offset:39520
  s_add_u32 m0, s43, 0
  s_add_u32 s42, s41, 0x1ffc00
  buffer_load_dwordx4 v1, s[8:11], s42 offen offset:1024 lds
  v_exp_f32 v51, v51
  v_exp_f32 v52, v52
  v_exp_f32 v53, v53
  v_exp_f32 v54, v54
  v_exp_f32 v55, v55
  s_waitcnt lgkmcnt(4)
  v_smfmac_f32_32x32x32_bf16 v[60:75], v[20:23], v[44:51], v2
  ds_read_b128 v[20:23], v4 offset:37440
  s_waitcnt vmcnt(8)
  ds_read_b64_tr_b16 v[124:125], v10 offset:0
  ds_read_b64_tr_b16 v[126:127], v10 offset:512
  v_exp_f32 v56, v56
  v_exp_f32 v57, v57
  s_add_u32 m0, s44, 0x1c00
  s_add_u32 s47, s47, s50
  buffer_load_dwordx4 v8, s[16:19], s47 offen lds
  v_exp_f32 v58, v58
  v_exp_f32 v59, v59
  v_exp_f32 v28, v28
  v_exp_f32 v29, v29
  s_waitcnt lgkmcnt(4)
  v_smfmac_f32_32x32x32_bf16 v[60:75], v[24:27], v[52:59], v2
  ds_read_b128 v[24:27], v5 offset:37440
  v_exp_f32 v30, v30
  v_exp_f32 v31, v31
  v_exp_f32 v32, v32
  v_exp_f32 v33, v33
  v_exp_f32 v34, v34
  s_waitcnt lgkmcnt(4)
  v_mfma_f32_32x32x16_bf16 v[44:59], v[16:19], v[12:15], v[76:91]
  ds_read_b128 v[16:19], v1 offset:41600
  v_exp_f32 v35, v35
  v_exp_f32 v36, v36
  v_exp_f32 v37, v37
  v_exp_f32 v38, v38
  v_exp_f32 v39, v39
  s_waitcnt lgkmcnt(4)
  v_smfmac_f32_32x32x32_bf16 v[60:75], v[20:23], v[28:35], v2
  ds_read_b128 v[20:23], v4 offset:39520
  s_waitcnt vmcnt(8)
  ds_read_b64_tr_b16 v[128:129], v10 offset:1024
  ds_read_b64_tr_b16 v[130:131], v10 offset:1536
  v_exp_f32 v40, v40
  v_exp_f32 v41, v41
  s_add_u32 m0, s44, 0
  s_add_u32 s47, s47, s49
  s_cmp_ge_u32 s47, s48
  s_cselect_b32 s7, 0x1c0000, 0
  s_sub_u32 s47, s47, s7
  buffer_load_dwordx4 v8, s[16:19], s47 offen lds
  v_exp_f32 v42, v42
  v_exp_f32 v43, v43
  v_exp_f32 v44, v44
  v_exp_f32 v45, v45
  s_waitcnt lgkmcnt(4)
  v_smfmac_f32_32x32x32_bf16 v[60:75], v[24:27], v[36:43], v2
  ds_read_b128 v[24:27], v5 offset:39520
  v_exp_f32 v46, v46
  v_exp_f32 v47, v47
  v_exp_f32 v48, v48
  v_exp_f32 v49, v49
  v_exp_f32 v50, v50
  s_waitcnt lgkmcnt(4)
  v_mfma_f32_32x32x16_bf16 v[28:43], v[16:19], v[12:15], v[76:91]
  ds_read_b128 v[16:19], v1 offset:43680
  s_waitcnt vmcnt(10)
  s_mov_b32 s7, 0x1010101
  v_cmp_eq_u32 vcc, s7, v252
  s_cmp_eq_u32 s6, 0
  s_cselect_b64 vcc, vcc, -1
  s_cmp_eq_u64 vcc, -1
  s_cbranch_scc0 k6_kernel_zq8
k6_kernel_zb9:
  v_mov_b32 v252, s53
  s_lshl_b32 s7, s38, 2
  s_add_u32 s7, s7, s63
  s_cmp_eq_u32 s6, 0
  s_cselect_b64 exec, 1, 0
  buffer_store_dword v252, off, s[8:11], s7
  s_mov_b64 exec, -1
  v_exp_f32 v51, v51
  v_exp_f32 v52, v52
  v_exp_f32 v53, v53
  v_exp_f32 v54, v54
  v_exp_f32 v55, v55
  s_waitcnt lgkmcnt(4)
  v_smfmac_f32_32x32x32_bf16 v[60:75], v[20:23], v[44:51], v2
  ds_read_b128 v[20:23], v4 offset:41600
  s_waitcnt vmcnt(8)
  ds_read_b64_tr_b16 v[132:133], v10 offset:2048
  ds_read_b64_tr_b16 v[134:135], v10 offset:2560
  v_exp_f32 v56, v56
  v_exp_f32 v57, v57
  s_add_u32 m0, s44, 0x400
  s_add_u32 s47, s47, s50
  buffer_load_dwordx4 v8, s[16:19], s47 offen lds
  v_exp_f32 v58, v58
  v_exp_f32 v59, v59
  v_exp_f32 v28, v28
  v_exp_f32 v29, v29
  s_waitcnt lgkmcnt(4)
  v_smfmac_f32_32x32x32_bf16 v[60:75], v[24:27], v[52:59], v2
  ds_read_b128 v[24:27], v5 offset:41600
  v_exp_f32 v30, v30
  v_exp_f32 v31, v31
  v_exp_f32 v32, v32
  v_exp_f32 v33, v33
  v_exp_f32 v34, v34
  s_waitcnt lgkmcnt(4)
  v_mfma_f32_32x32x16_bf16 v[44:59], v[16:19], v[12:15], v[76:91]
  ds_read_b128 v[16:19], v1 offset:45760
  v_exp_f32 v35, v35
  v_exp_f32 v36, v36
  v_exp_f32 v37, v37
  v_exp_f32 v38, v38
  v_exp_f32 v39, v39
  s_waitcnt lgkmcnt(4)
  v_smfmac_f32_32x32x32_bf16 v[60:75], v[20:23], v[28:35], v2
  ds_read_b128 v[20:23], v4 offset:43680
  s_waitcnt vmcnt(8)
  ds_read_b64_tr_b16 v[136:137], v10 offset:3072
  ds_read_b64_tr_b16 v[138:139], v10 offset:3584
  v_exp_f32 v40, v40
  v_exp_f32 v41, v41
  s_add_u32 m0, s44, 0x800
  s_add_u32 s47, s47, s49
  buffer_load_dwordx4 v8, s[16:19], s47 offen lds
  v_exp_f32 v42, v42
  v_exp_f32 v43, v43
  v_exp_f32 v44, v44
  v_exp_f32 v45, v45
  s_waitcnt lgkmcnt(4)
  v_smfmac_f32_32x32x32_bf16 v[60:75], v[24:27], v[36:43], v2
  ds_read_b128 v[24:27], v5 offset:43680
  v_exp_f32 v46, v46
  v_exp_f32 v47, v47
  v_exp_f32 v48, v48
  v_exp_f32 v49, v49
  v_exp_f32 v50, v50
  s_waitcnt lgkmcnt(4)
  v_mfma_f32_32x32x16_bf16 v[28:43], v[16:19], v[12:15], v[76:91]
  ds_read_b128 v[16:19], v1 offset:47840
  v_exp_f32 v51, v51
  v_exp_f32 v52, v52
  v_exp_f32 v53, v53
  v_exp_f32 v54, v54
  v_exp_f32 v55, v55
  s_waitcnt lgkmcnt(4)
  v_smfmac_f32_32x32x32_bf16 v[60:75], v[20:23], v[44:51], v2
  ds_read_b128 v[20:23], v4 offset:45760
  s_waitcnt vmcnt(8)
  ds_read_b64_tr_b16 v[140:141], v10 offset:4096
  ds_read_b64_tr_b16 v[142:143], v10 offset:4608
  v_exp_f32 v56, v56
  v_exp_f32 v57, v57
  s_add_u32 m0, s44, 0xc00
  s_add_u32 s47, s47, s50
  buffer_load_dwordx4 v8, s[16:19], s47 offen lds
  v_exp_f32 v58, v58
  v_exp_f32 v59, v59
  v_exp_f32 v28, v28
  v_exp_f32 v29, v29
  s_waitcnt lgkmcnt(4)
  v_smfmac_f32_32x32x32_bf16 v[60:75], v[24:27], v[52:59], v2
  ds_read_b128 v[24:27], v5 offset:45760
  v_exp_f32 v30, v30
  v_exp_f32 v31, v31
  v_exp_f32 v32, v32
  v_exp_f32 v33, v33
  v_exp_f32 v34, v34
  s_waitcnt lgkmcnt(4)
  v_mfma_f32_32x32x16_bf16 v[44:59], v[16:19], v[12:15], v[76:91]
  s_barrier
  ds_read_b128 v[16:19], v1 offset:49920
  v_exp_f32 v35, v35
  v_exp_f32 v36, v36
  v_exp_f32 v37, v37
  v_exp_f32 v38, v38
  v_exp_f32 v39, v39
  s_waitcnt lgkmcnt(4)
  v_smfmac_f32_32x32x32_bf16 v[60:75], v[20:23], v[28:35], v2
  ds_read_b128 v[20:23], v4 offset:47840
  s_waitcnt vmcnt(7)
  ds_read_b64_tr_b16 v[144:145], v10 offset:5120
  ds_read_b64_tr_b16 v[146:147], v10 offset:5632
  v_exp_f32 v40, v40
  v_exp_f32 v41, v41
  s_add_u32 m0, s44, 0x1000
  s_add_u32 s47, s47, s49
  buffer_load_dwordx4 v8, s[16:19], s47 offen lds
  v_exp_f32 v42, v42
  v_exp_f32 v43, v43
  v_exp_f32 v44, v44
  v_exp_f32 v45, v45
  s_waitcnt lgkmcnt(4)
  v_smfmac_f32_32x32x32_bf16 v[60:75], v[24:27], v[36:43], v2
  ds_read_b128 v[24:27], v5 offset:47840
  v_exp_f32 v46, v46
  v_exp_f32 v47, v47
  v_exp_f32 v48, v48
  v_exp_f32 v49, v49
  v_exp_f32 v50, v50
  s_waitcnt lgkmcnt(4)
  v_mfma_f32_32x32x16_bf16 v[28:43], v[16:19], v[12:15], v[76:91]
  ds_read_b128 v[16:19], v1 offset:52000
  s_add_u32 m0, s43, 0x4100
  s_add_u32 s76, s76, 0x2000
  s_and_b32 s76, s76, 0xffff
  s_add_u32 s41, s40, s76
  buffer_load_dwordx4 v1, s[8:11], s41 offen lds
  v_exp_f32 v51, v51
  v_exp_f32 v52, v52
  v_exp_f32 v53, v53
  v_exp_f32 v54, v54
  v_exp_f32 v55, v55
  s_waitcnt lgkmcnt(4)
  v_smfmac_f32_32x32x32_bf16 v[60:75], v[20:23], v[44:51], v2
  ds_read_b128 v[20:23], v4 offset:49920
  s_waitcnt vmcnt(8)
  ds_read_b64_tr_b16 v[148:149], v10 offset:6144
  ds_read_b64_tr_b16 v[150:151], v10 offset:6656
  v_exp_f32 v56, v56
  v_exp_f32 v57, v57
  s_add_u32 m0, s44, 0x1400
  s_add_u32 s47, s47, s50
  buffer_load_dwordx4 v8, s[16:19], s47 offen lds
  v_exp_f32 v58, v58
  v_exp_f32 v59, v59
  v_exp_f32 v28, v28
  v_exp_f32 v29, v29
  s_waitcnt lgkmcnt(4)
  v_smfmac_f32_32x32x32_bf16 v[60:75], v[24:27], v[52:59], v2
  ds_read_b128 v[24:27], v5 offset:49920
  v_exp_f32 v30, v30
  v_exp_f32 v31, v31
  v_exp_f32 v32, v32
  v_exp_f32 v33, v33
  v_exp_f32 v34, v34
  s_waitcnt lgkmcnt(4)
  v_mfma_f32_32x32x16_bf16 v[44:59], v[16:19], v[12:15], v[76:91]
  ds_read_b128 v[16:19], v1 offset:54080
  v_exp_f32 v35, v35
  v_exp_f32 v36, v36
  v_exp_f32 v37, v37
  v_exp_f32 v38, v38
  v_exp_f32 v39, v39
  s_waitcnt lgkmcnt(4)
  v_smfmac_f32_32x32x32_bf16 v[60:75], v[20:23], v[28:35], v2
  ds_read_b128 v[20:23], v4 offset:52000
  s_waitcnt vmcnt(7)
  ds_read_b64_tr_b16 v[152:153], v10 offset:7168
  ds_read_b64_tr_b16 v[154:155], v10 offset:7680
  v_exp_f32 v40, v40
  v_exp_f32 v41, v41
  s_add_u32 m0, s44, 0x1800
  s_add_u32 s47, s47, s49
  buffer_load_dwordx4 v8, s[16:19], s47 offen lds
  v_exp_f32 v42, v42
  v_exp_f32 v43, v43
  v_exp_f32 v44, v44
  v_exp_f32 v45, v45
  s_waitcnt lgkmcnt(4)
  v_smfmac_f32_32x32x32_bf16 v[60:75], v[24:27], v[36:43], v2
  ds_read_b128 v[24:27], v5 offset:52000
  v_exp_f32 v46, v46
  v_exp_f32 v47, v47
  v_exp_f32 v48, v48
  v_exp_f32 v49, v49
  v_exp_f32 v50, v50
  s_waitcnt lgkmcnt(4)
  v_mfma_f32_32x32x16_bf16 v[28:43], v[16:19], v[12:15], v[76:91]
  ds_read_b128 v[16:19], v1 offset:56160
  s_add_u32 m0, s43, 0x4100
  s_add_u32 s42, s41, 0x1ffc00
  buffer_load_dwordx4 v1, s[8:11], s42 offen offset:1024 lds
  v_exp_f32 v51, v51
  v_exp_f32 v52, v52
  v_exp_f32 v53, v53
  v_exp_f32 v54, v54
  v_exp_f32 v55, v55
  s_waitcnt lgkmcnt(4)
  v_smfmac_f32_32x32x32_bf16 v[60:75], v[20:23], v[44:51], v2
  ds_read_b128 v[20:23], v4 offset:54080
  s_waitcnt vmcnt(8)
  ds_read_b64_tr_b16 v[156:157], v10 offset:0
  ds_read_b64_tr_b16 v[158:159], v10 offset:512
  v_exp_f32 v56, v56
  v_exp_f32 v57, v57
  s_add_u32 m0, s44, 0x1c00
  s_add_u32 s47, s47, s50
  buffer_load_dwordx4 v8, s[16:19], s47 offen lds
  v_exp_f32 v58, v58
  v_exp_f32 v59, v59
  v_exp_f32 v28, v28
  v_exp_f32 v29, v29
  s_waitcnt lgkmcnt(4)
  v_smfmac_f32_32x32x32_bf16 v[60:75], v[24:27], v[52:59], v2
  ds_read_b128 v[24:27], v5 offset:54080
  v_exp_f32 v30, v30
  v_exp_f32 v31, v31
  v_exp_f32 v32, v32
  v_exp_f32 v33, v33
  v_exp_f32 v34, v34
  s_waitcnt lgkmcnt(4)
  v_mfma_f32_32x32x16_bf16 v[44:59], v[16:19], v[12:15], v[76:91]
  ds_read_b128 v[16:19], v1 offset:58240
  v_exp_f32 v35, v35
  v_exp_f32 v36, v36
  v_exp_f32 v37, v37
  v_exp_f32 v38, v38
  v_exp_f32 v39, v39
  s_waitcnt lgkmcnt(4)
  v_smfmac_f32_32x32x32_bf16 v[60:75], v[20:23], v[28:35], v2
  ds_read_b128 v[20:23], v4 offset:56160
  s_waitcnt vmcnt(8)
  ds_read_b64_tr_b16 v[160:161], v10 offset:1024
  ds_read_b64_tr_b16 v[162:163], v10 offset:1536
  v_exp_f32 v40, v40
  v_exp_f32 v41, v41
  s_add_u32 m0, s44, 0
  s_add_u32 s47, s47, s49
  s_cmp_ge_u32 s47, s48
  s_cselect_b32 s7, 0x1c0000, 0
  s_sub_u32 s47, s47, s7
  buffer_load_dwordx4 v8, s[16:19], s47 offen lds
  v_exp_f32 v42, v42
  v_exp_f32 v43, v43
  v_exp_f32 v44, v44
  v_exp_f32 v45, v45
  s_waitcnt lgkmcnt(4)
  v_smfmac_f32_32x32x32_bf16 v[60:75], v[24:27], v[36:43], v2
  ds_read_b128 v[24:27], v5 offset:56160
  v_exp_f32 v46, v46
  v_exp_f32 v47, v47
  v_exp_f32 v48, v48
  v_exp_f32 v49, v49
  v_exp_f32 v50, v50
  s_waitcnt lgkmcnt(4)
  v_mfma_f32_32x32x16_bf16 v[28:43], v[16:19], v[12:15], v[76:91]
  ds_read_b128 v[16:19], v1 offset:60320
  v_exp_f32 v51, v51
  v_exp_f32 v52, v52
  v_exp_f32 v53, v53
  v_exp_f32 v54, v54
  v_exp_f32 v55, v55
  s_waitcnt lgkmcnt(4)
  v_smfmac_f32_32x32x32_bf16 v[60:75], v[20:23], v[44:51], v2
  ds_read_b128 v[20:23], v4 offset:58240
  s_waitcnt vmcnt(8)
  ds_read_b64_tr_b16 v[164:165], v10 offset:2048
  ds_read_b64_tr_b16 v[166:167], v10 offset:2560
  v_exp_f32 v56, v56
  v_exp_f32 v57, v57
  s_add_u32 m0, s44, 0x400
  s_add_u32 s47, s47, s50
  buffer_load_dwordx4 v8, s[16:19], s47 offen lds
  v_exp_f32 v58, v58
  v_exp_f32 v59, v59
  v_exp_f32 v28, v28
  v_exp_f32 v29, v29
  s_waitcnt lgkmcnt(4)
  v_smfmac_f32_32x32x32_bf16 v[60:75], v[24:27], v[52:59], v2
  ds_read_b128 v[24:27], v5 offset:58240
  v_exp_f32 v30, v30
  v_exp_f32 v31, v31
  v_exp_f32 v32, v32
  v_exp_f32 v33, v33
  v_exp_f32 v34, v34
  s_waitcnt lgkmcnt(4)
  v_mfma_f32_32x32x16_bf16 v[44:59], v[16:19], v[12:15], v[76:91]
  ds_read_b128 v[16:19], v1 offset:62400
  v_exp_f32 v35, v35
  v_exp_f32 v36, v36
  v_exp_f32 v37, v37
  v_exp_f32 v38, v38
  v_exp_f32 v39, v39
  s_waitcnt lgkmcnt(4)
  v_smfmac_f32_32x32x32_bf16 v[60:75], v[20:23], v[28:35], v2
  ds_read_b128 v[20:23], v4 offset:60320
  s_waitcnt vmcnt(8)
  ds_read_b64_tr_b16 v[168:169], v10 offset:3072
  ds_read_b64_tr_b16 v[170:171], v10 offset:3584
  v_exp_f32 v40, v40
  v_exp_f32 v41, v41
  s_add_u32 m0, s44, 0x800
  s_add_u32 s47, s47, s49
  buffer_load_dwordx4 v8, s[16:19], s47 offen lds
  v_exp_f32 v42, v42
  v_exp_f32 v43, v43
  v_exp_f32 v44, v44
  v_exp_f32 v45, v45
  s_waitcnt lgkmcnt(4)
  v_smfmac_f32_32x32x32_bf16 v[60:75], v[24:27], v[36:43], v2
  ds_read_b128 v[24:27], v5 offset:60320
  v_exp_f32 v46, v46
  v_exp_f32 v47, v47
  v_exp_f32 v48, v48
  v_exp_f32 v49, v49
  v_exp_f32 v50, v50
  s_waitcnt lgkmcnt(4)
  v_mfma_f32_32x32x16_bf16 v[28:43], v[16:19], v[12:15], v[76:91]
  ds_read_b128 v[16:19], v1 offset:64480
  v_exp_f32 v51, v51
  v_exp_f32 v52, v52
  v_exp_f32 v53, v53
  v_exp_f32 v54, v54
  v_exp_f32 v55, v55
  s_waitcnt lgkmcnt(4)
  v_smfmac_f32_32x32x32_bf16 v[60:75], v[20:23], v[44:51], v2
  ds_read_b128 v[20:23], v4 offset:62400
  s_waitcnt vmcnt(8)
  ds_read_b64_tr_b16 v[172:173], v10 offset:4096
  ds_read_b64_tr_b16 v[174:175], v10 offset:4608
  v_exp_f32 v56, v56
  v_exp_f32 v57, v57
  s_add_u32 m0, s44, 0xc00
  s_add_u32 s47, s47, s50
  buffer_load_dwordx4 v8, s[16:19], s47 offen lds
  v_exp_f32 v58, v58
  v_exp_f32 v59, v59
  v_exp_f32 v28, v28
  v_exp_f32 v29, v29
  s_waitcnt lgkmcnt(4)
  v_smfmac_f32_32x32x32_bf16 v[60:75], v[24:27], v[52:59], v2
  ds_read_b128 v[24:27], v5 offset:62400
  v_exp_f32 v30, v30
  v_exp_f32 v31, v31
  v_exp_f32 v32, v32
  v_exp_f32 v33, v33
  v_exp_f32 v34, v34
  s_waitcnt lgkmcnt(4)
  v_mfma_f32_32x32x16_bf16 v[44:59], v[16:19], v[12:15], v[76:91]
  s_barrier
  ds_read_b128 v[16:19], v1 offset:0
  v_exp_f32 v35, v35
  v_exp_f32 v36, v36
  v_exp_f32 v37, v37
  v_exp_f32 v38, v38
  v_exp_f32 v39, v39
  s_waitcnt lgkmcnt(4)
  v_smfmac_f32_32x32x32_bf16 v[60:75], v[20:23], v[28:35], v2
  ds_read_b128 v[20:23], v4 offset:64480
  s_waitcnt vmcnt(7)
  ds_read_b64_tr_b16 v[176:177], v10 offset:5120
  ds_read_b64_tr_b16 v[178:179], v10 offset:5632
  v_exp_f32 v40, v40
  v_exp_f32 v41, v41
  s_add_u32 m0, s44, 0x1000
  s_add_u32 s47, s47, s49
  buffer_load_dwordx4 v8, s[16:19], s47 offen lds
  v_exp_f32 v42, v42
  v_exp_f32 v43, v43
  v_exp_f32 v44, v44
  v_exp_f32 v45, v45
  s_waitcnt lgkmcnt(4)
  v_smfmac_f32_32x32x32_bf16 v[60:75], v[24:27], v[36:43], v2
  ds_read_b128 v[24:27], v5 offset:64480
  v_exp_f32 v46, v46
  v_exp_f32 v47, v47
  v_exp_f32 v48, v48
  v_exp_f32 v49, v49
  v_exp_f32 v50, v50
  s_waitcnt lgkmcnt(4)
  v_mfma_f32_32x32x16_bf16 v[28:43], v[16:19], v[12:15], v[76:91]
  ds_read_b128 v[16:19], v1 offset:2080
  s_add_u32 m0, s43, 0x8200
  s_add_u32 s76, s76, 0x2000
  s_and_b32 s76, s76, 0xffff
  s_add_u32 s41, s40, s76
  buffer_load_dwordx4 v1, s[8:11], s41 offen lds
  v_exp_f32 v51, v51
  v_exp_f32 v52, v52
  v_exp_f32 v53, v53
  v_exp_f32 v54, v54
  v_exp_f32 v55, v55
  s_waitcnt lgkmcnt(4)
  v_smfmac_f32_32x32x32_bf16 v[60:75], v[20:23], v[44:51], v2
  ds_read_b128 v[20:23], v4 offset:0
  s_waitcnt vmcnt(8)
  ds_read_b64_tr_b16 v[180:181], v10 offset:6144
  ds_read_b64_tr_b16 v[182:183], v10 offset:6656
  v_exp_f32 v56, v56
  v_exp_f32 v57, v57
  s_add_u32 m0, s44, 0x1400
  s_add_u32 s47, s47, s50
  buffer_load_dwordx4 v8, s[16:19], s47 offen lds
  v_exp_f32 v58, v58
  v_exp_f32 v59, v59
  v_exp_f32 v28, v28
  v_exp_f32 v29, v29
  s_waitcnt lgkmcnt(4)
  v_smfmac_f32_32x32x32_bf16 v[60:75], v[24:27], v[52:59], v2
  ds_read_b128 v[24:27], v5 offset:0
  v_exp_f32 v30, v30
  v_exp_f32 v31, v31
  v_exp_f32 v32, v32
  v_exp_f32 v33, v33
  v_exp_f32 v34, v34
  s_waitcnt lgkmcnt(4)
  v_mfma_f32_32x32x16_bf16 v[44:59], v[16:19], v[12:15], v[76:91]
  ds_read_b128 v[16:19], v1 offset:4160
  v_exp_f32 v35, v35
  v_exp_f32 v36, v36
  v_exp_f32 v37, v37
  v_exp_f32 v38, v38
  v_exp_f32 v39, v39
  s_waitcnt lgkmcnt(4)
  v_smfmac_f32_32x32x32_bf16 v[60:75], v[20:23], v[28:35], v2
  ds_read_b128 v[20:23], v4 offset:2080
  s_waitcnt vmcnt(7)
  ds_read_b64_tr_b16 v[184:185], v10 offset:7168
  ds_read_b64_tr_b16 v[186:187], v10 offset:7680
  v_exp_f32 v40, v40
  v_exp_f32 v41, v41
  s_add_u32 m0, s44, 0x1800
  s_add_u32 s47, s47, s49
  buffer_load_dwordx4 v8, s[16:19], s47 offen lds
  v_exp_f32 v42, v42
  v_exp_f32 v43, v43
  v_exp_f32 v44, v44
  v_exp_f32 v45, v45
  s_waitcnt lgkmcnt(4)
  v_smfmac_f32_32x32x32_bf16 v[60:75], v[24:27], v[36:43], v2
  ds_read_b128 v[24:27], v5 offset:2080
  v_exp_f32 v46, v46
  v_exp_f32 v47, v47
  v_exp_f32 v48, v48
  v_exp_f32 v49, v49
  v_exp_f32 v50, v50
  s_waitcnt lgkmcnt(4)
  v_mfma_f32_32x32x16_bf16 v[28:43], v[16:19], v[12:15], v[76:91]
  ds_read_b128 v[16:19], v1 offset:6240
  s_add_u32 m0, s43, 0x8200
  s_add_u32 s42, s41, 0x1ffc00
  buffer_load_dwordx4 v1, s[8:11], s42 offen offset:1024 lds
  v_exp_f32 v51, v51
  v_exp_f32 v52, v52
  v_exp_f32 v53, v53
  v_exp_f32 v54, v54
  v_exp_f32 v55, v55
  s_waitcnt lgkmcnt(4)
  v_smfmac_f32_32x32x32_bf16 v[60:75], v[20:23], v[44:51], v2
  ds_read_b128 v[20:23], v4 offset:4160
  s_waitcnt vmcnt(8)
  ds_read_b64_tr_b16 v[188:189], v10 offset:0
  ds_read_b64_tr_b16 v[190:191], v10 offset:512
  v_exp_f32 v56, v56
  v_exp_f32 v57, v57
  s_add_u32 m0, s44, 0x1c00
  s_add_u32 s47, s47, s50
  buffer_load_dwordx4 v8, s[16:19], s47 offen lds
  v_exp_f32 v58, v58
  v_exp_f32 v59, v59
  v_exp_f32 v28, v28
  v_exp_f32 v29, v29
  s_waitcnt lgkmcnt(4)
  v_smfmac_f32_32x32x32_bf16 v[60:75], v[24:27], v[52:59], v2
  ds_read_b128 v[24:27], v5 offset:4160
  v_exp_f32 v30, v30
  v_exp_f32 v31, v31
  v_exp_f32 v32, v32
  v_exp_f32 v33, v33
  v_exp_f32 v34, v34
  s_waitcnt lgkmcnt(4)
  v_mfma_f32_32x32x16_bf16 v[44:59], v[16:19], v[12:15], v[76:91]
  ds_read_b128 v[16:19], v1 offset:8320
  v_exp_f32 v35, v35
  v_exp_f32 v36, v36
  v_exp_f32 v37, v37
  v_exp_f32 v38, v38
  v_exp_f32 v39, v39
  s_waitcnt lgkmcnt(4)
  v_smfmac_f32_32x32x32_bf16 v[60:75], v[20:23], v[28:35], v2
  ds_read_b128 v[20:23], v4 offset:6240
  s_waitcnt vmcnt(8)
  ds_read_b64_tr_b16 v[192:193], v10 offset:1024
  ds_read_b64_tr_b16 v[194:195], v10 offset:1536
  v_exp_f32 v40, v40
  v_exp_f32 v41, v41
  s_add_u32 m0, s44, 0
  s_add_u32 s47, s47, s49
  s_cmp_ge_u32 s47, s48
  s_cselect_b32 s7, 0x1c0000, 0
  s_sub_u32 s47, s47, s7
  buffer_load_dwordx4 v8, s[16:19], s47 offen lds
  v_exp_f32 v42, v42
  v_exp_f32 v43, v43
  v_exp_f32 v44, v44
  v_exp_f32 v45, v45
  s_waitcnt lgkmcnt(4)
  v_smfmac_f32_32x32x32_bf16 v[60:75], v[24:27], v[36:43], v2
  ds_read_b128 v[24:27], v5 offset:6240
  v_exp_f32 v46, v46
  v_exp_f32 v47, v47
  v_exp_f32 v48, v48
  v_exp_f32 v49, v49
  v_exp_f32 v50, v50
  s_waitcnt lgkmcnt(4)
  v_mfma_f32_32x32x16_bf16 v[28:43], v[16:19], v[12:15], v[76:91]
  ds_read_b128 v[16:19], v1 offset:10400
  buffer_load_dword v252, v255, s[8:11], s63 offen sc1
  v_exp_f32 v51, v51
  v_exp_f32 v52, v52
  v_exp_f32 v53, v53
  v_exp_f32 v54, v54
  v_exp_f32 v55, v55
  s_waitcnt lgkmcnt(4)
  v_smfmac_f32_32x32x32_bf16 v[60:75], v[20:23], v[44:51], v2
  ds_read_b128 v[20:23], v4 offset:8320
  s_waitcnt vmcnt(9)
  ds_read_b64_tr_b16 v[196:197], v10 offset:2048
  ds_read_b64_tr_b16 v[198:199], v10 offset:2560
  v_exp_f32 v56, v56
  v_exp_f32 v57, v57
  s_add_u32 m0, s44, 0x400
  s_add_u32 s47, s47, s50
  buffer_load_dwordx4 v8, s[16:19], s47 offen lds
  v_exp_f32 v58, v58
  v_exp_f32 v59, v59
  v_exp_f32 v28, v28
  v_exp_f32 v29, v29
  s_waitcnt lgkmcnt(4)
  v_smfmac_f32_32x32x32_bf16 v[60:75], v[24:27], v[52:59], v2
  ds_read_b128 v[24:27], v5 offset:8320
  v_exp_f32 v30, v30
  v_exp_f32 v31, v31
  v_exp_f32 v32, v32
  v_exp_f32 v33, v33
  v_exp_f32 v34, v34
  s_waitcnt lgkmcnt(4)
  v_mfma_f32_32x32x16_bf16 v[44:59], v[16:19], v[12:15], v[76:91]
  ds_read_b128 v[16:19], v1 offset:12480
  v_exp_f32 v35, v35
  v_exp_f32 v36, v36
  v_exp_f32 v37, v37
  v_exp_f32 v38, v38
  v_exp_f32 v39, v39
  s_waitcnt lgkmcnt(4)
  v_smfmac_f32_32x32x32_bf16 v[60:75], v[20:23], v[28:35], v2
  ds_read_b128 v[20:23], v4 offset:10400
  s_waitcnt vmcnt(9)
  ds_read_b64_tr_b16 v[200:201], v10 offset:3072
  ds_read_b64_tr_b16 v[202:203], v10 offset:3584
  v_exp_f32 v40, v40
  v_exp_f32 v41, v41
  s_add_u32 m0, s44, 0x800
  s_add_u32 s47, s47, s49
  buffer_load_dwordx4 v8, s[16:19], s47 offen lds
  v_exp_f32 v42, v42
  v_exp_f32 v43, v43
  v_exp_f32 v44, v44
  v_exp_f32 v45, v45
  s_waitcnt lgkmcnt(4)
  v_smfmac_f32_32x32x32_bf16 v[60:75], v[24:27], v[36:43], v2
  ds_read_b128 v[24:27], v5 offset:10400
  v_exp_f32 v46, v46
  v_exp_f32 v47, v47
  v_exp_f32 v48, v48
  v_exp_f32 v49, v49
  v_exp_f32 v50, v50
  s_waitcnt lgkmcnt(4)
  v_mfma_f32_32x32x16_bf16 v[28:43], v[16:19], v[12:15], v[76:91]
  ds_read_b128 v[16:19], v1 offset:14560
  v_exp_f32 v51, v51
  v_exp_f32 v52, v52
  v_exp_f32 v53, v53
  v_exp_f32 v54, v54
  v_exp_f32 v55, v55
  s_waitcnt lgkmcnt(4)
  v_smfmac_f32_32x32x32_bf16 v[60:75], v[20:23], v[44:51], v2
  ds_read_b128 v[20:23], v4 offset:12480
  s_waitcnt vmcnt(9)
  ds_read_b64_tr_b16 v[204:205], v10 offset:4096
  ds_read_b64_tr_b16 v[206:207], v10 offset:4608
  v_exp_f32 v56, v56
  v_exp_f32 v57, v57
  s_add_u32 m0, s44, 0xc00
  s_add_u32 s47, s47, s50
  buffer_load_dwordx4 v8, s[16:19], s47 offen lds
  v_exp_f32 v58, v58
  v_exp_f32 v59, v59
  v_exp_f32 v28, v28
  v_exp_f32 v29, v29
  s_waitcnt lgkmcnt(4)
  v_smfmac_f32_32x32x32_bf16 v[60:75], v[24:27], v[52:59], v2
  ds_read_b128 v[24:27], v5 offset:12480
  v_exp_f32 v30, v30
  v_exp_f32 v31, v31
  v_exp_f32 v32, v32
  v_exp_f32 v33, v33
  v_exp_f32 v34, v34
  s_waitcnt lgkmcnt(4)
  v_mfma_f32_32x32x16_bf16 v[44:59], v[16:19], v[12:15], v[76:91]
  s_barrier
  ds_read_b128 v[16:19], v1 offset:16640
  v_exp_f32 v35, v35
  v_exp_f32 v36, v36
  v_exp_f32 v37, v37
  v_exp_f32 v38, v38
  v_exp_f32 v39, v39
  s_waitcnt lgkmcnt(4)
  v_smfmac_f32_32x32x32_bf16 v[60:75], v[20:23], v[28:35], v2
  ds_read_b128 v[20:23], v4 offset:14560
  s_waitcnt vmcnt(8)
  ds_read_b64_tr_b16 v[208:209], v10 offset:5120
  ds_read_b64_tr_b16 v[210:211], v10 offset:5632
  v_exp_f32 v40, v40
  v_exp_f32 v41, v41
  s_add_u32 m0, s44, 0x1000
  s_add_u32 s47, s47, s49
  buffer_load_dwordx4 v8, s[16:19], s47 offen lds
  v_exp_f32 v42, v42
  v_exp_f32 v43, v43
  v_exp_f32 v44, v44
  v_exp_f32 v45, v45
  s_waitcnt lgkmcnt(4)
  v_smfmac_f32_32x32x32_bf16 v[60:75], v[24:27], v[36:43], v2
  ds_read_b128 v[24:27], v5 offset:14560
  v_exp_f32 v46, v46
  v_exp_f32 v47, v47
  v_exp_f32 v48, v48
  v_exp_f32 v49, v49
  v_exp_f32 v50, v50
  s_waitcnt lgkmcnt(4)
  v_mfma_f32_32x32x16_bf16 v[28:43], v[16:19], v[12:15], v[76:91]
  ds_read_b128 v[16:19], v1 offset:18720
  s_add_u32 m0, s43, 0xc300
  s_add_u32 s76, s76, 0x2000
  s_and_b32 s76, s76, 0xffff
  s_add_u32 s41, s40, s76
  buffer_load_dwordx4 v1, s[8:11], s41 offen lds
  v_exp_f32 v51, v51
  v_exp_f32 v52, v52
  v_exp_f32 v53, v53
  v_exp_f32 v54, v54
  v_exp_f32 v55, v55
  s_waitcnt lgkmcnt(4)
  v_smfmac_f32_32x32x32_bf16 v[60:75], v[20:23], v[44:51], v2
  ds_read_b128 v[20:23], v4 offset:16640
  s_waitcnt vmcnt(9)
  ds_read_b64_tr_b16 v[212:213], v10 offset:6144
  ds_read_b64_tr_b16 v[214:215], v10 offset:6656
  v_exp_f32 v56, v56
  v_exp_f32 v57, v57
  s_add_u32 m0, s44, 0x1400
  s_add_u32 s47, s47, s50
  buffer_load_dwordx4 v8, s[16:19], s47 offen lds
  v_exp_f32 v58, v58
  v_exp_f32 v59, v59
  v_exp_f32 v28, v28
  v_exp_f32 v29, v29
  s_waitcnt lgkmcnt(4)
  v_smfmac_f32_32x32x32_bf16 v[60:75], v[24:27], v[52:59], v2
  ds_read_b128 v[24:27], v5 offset:16640
  v_exp_f32 v30, v30
  v_exp_f32 v31, v31
  v_exp_f32 v32, v32
  v_exp_f32 v33, v33
  v_exp_f32 v34, v34
  s_waitcnt lgkmcnt(4)
  v_mfma_f32_32x32x16_bf16 v[44:59], v[16:19], v[12:15], v[76:91]
  ds_read_b128 v[16:19], v1 offset:20800
  v_exp_f32 v35, v35
  v_exp_f32 v36, v36
  v_exp_f32 v37, v37
  v_exp_f32 v38, v38
  v_exp_f32 v39, v39
  s_waitcnt lgkmcnt(4)
  v_smfmac_f32_32x32x32_bf16 v[60:75], v[20:23], v[28:35], v2
  ds_read_b128 v[20:23], v4 offset:18720
  s_waitcnt vmcnt(8)
  ds_read_b64_tr_b16 v[216:217], v10 offset:7168
  ds_read_b64_tr_b16 v[218:219], v10 offset:7680
  v_exp_f32 v40, v40
  v_exp_f32 v41, v41
  s_add_u32 m0, s44, 0x1800
  s_add_u32 s47, s47, s49
  buffer_load_dwordx4 v8, s[16:19], s47 offen lds
  v_exp_f32 v42, v42
  v_exp_f32 v43, v43
  v_exp_f32 v44, v44
  v_exp_f32 v45, v45
  s_waitcnt lgkmcnt(4)
  v_smfmac_f32_32x32x32_bf16 v[60:75], v[24:27], v[36:43], v2
  ds_read_b128 v[24:27], v5 offset:18720
  v_exp_f32 v46, v46
  v_exp_f32 v47, v47
  v_exp_f32 v48, v48
  v_exp_f32 v49, v49
  v_exp_f32 v50, v50
  s_waitcnt lgkmcnt(4)
  v_mfma_f32_32x32x16_bf16 v[28:43], v[16:19], v[12:15], v[76:91]
  ds_read_b128 v[16:19], v1 offset:22880
  s_add_u32 m0, s43, 0xc300
  s_add_u32 s42, s41, 0x1ffc00
  buffer_load_dwordx4 v1, s[8:11], s42 offen offset:1024 lds
  v_exp_f32 v51, v51
  v_exp_f32 v52, v52
  v_exp_f32 v53, v53
  v_exp_f32 v54, v54
  v_exp_f32 v55, v55
  s_waitcnt lgkmcnt(4)
  v_smfmac_f32_32x32x32_bf16 v[60:75], v[20:23], v[44:51], v2
  ds_read_b128 v[20:23], v4 offset:20800
  s_waitcnt vmcnt(9)
  ds_read_b64_tr_b16 v[220:221], v10 offset:0
  ds_read_b64_tr_b16 v[222:223], v10 offset:512
  v_exp_f32 v56, v56
  v_exp_f32 v57, v57
  s_add_u32 m0, s44, 0x1c00
  s_add_u32 s47, s47, s50
  buffer_load_dwordx4 v8, s[16:19], s47 offen lds
  v_exp_f32 v58, v58
  v_exp_f32 v59, v59
  v_exp_f32 v28, v28
  v_exp_f32 v29, v29
  s_waitcnt lgkmcnt(4)
  v_smfmac_f32_32x32x32_bf16 v[60:75], v[24:27], v[52:59], v2
  ds_read_b128 v[24:27], v5 offset:20800
  v_exp_f32 v30, v30
  v_exp_f32 v31, v31
  v_exp_f32 v32, v32
  v_exp_f32 v33, v33
  v_exp_f32 v34, v34
  s_waitcnt lgkmcnt(4)
  v_mfma_f32_32x32x16_bf16 v[44:59], v[16:19], v[12:15], v[76:91]
  ds_read_b128 v[16:19], v1 offset:24960
  v_exp_f32 v35, v35
  v_exp_f32 v36, v36
  v_exp_f32 v37, v37
  v_exp_f32 v38, v38
  v_exp_f32 v39, v39
  s_waitcnt lgkmcnt(4)
  v_smfmac_f32_32x32x32_bf16 v[60:75], v[20:23], v[28:35], v2
  ds_read_b128 v[20:23], v4 offset:22880
  s_waitcnt vmcnt(8)
  ds_read_b64_tr_b16 v[224:225], v10 offset:1024
  ds_read_b64_tr_b16 v[226:227], v10 offset:1536
  v_exp_f32 v40, v40
  v_exp_f32 v41, v41
  s_add_u32 m0, s44, 0
  s_add_u32 s45, s45, 0x4000
  s_cmp_ge_u32 s45, s46
  s_cselect_b32 s7, 0x40000, 0
  s_sub_u32 s45, s45, s7
  buffer_load_dwordx4 v9, s[12:15], s45 offen lds
  v_exp_f32 v42, v42
  v_exp_f32 v43, v43
  v_exp_f32 v44, v44
  v_exp_f32 v45, v45
  s_waitcnt lgkmcnt(4)
  v_smfmac_f32_32x32x32_bf16 v[60:75], v[24:27], v[36:43], v2
  ds_read_b128 v[24:27], v5 offset:22880
  v_exp_f32 v46, v46
  v_exp_f32 v47, v47
  v_exp_f32 v48, v48
  v_exp_f32 v49, v49
  v_exp_f32 v50, v50
  s_waitcnt lgkmcnt(4)
  v_mfma_f32_32x32x16_bf16 v[28:43], v[16:19], v[12:15], v[76:91]
  ds_read_b128 v[16:19], v1 offset:27040
  v_lshlrev_b32 v253, 2, v1
  buffer_load_dword v254, v253, s[20:23], s65 offen
  v_exp_f32 v51, v51
  v_exp_f32 v52, v52
  v_exp_f32 v53, v53
  v_exp_f32 v54, v54
  v_exp_f32 v55, v55
  s_waitcnt lgkmcnt(4)
  v_smfmac_f32_32x32x32_bf16 v[60:75], v[20:23], v[44:51], v2
  ds_read_b128 v[20:23], v4 offset:24960
  s_waitcnt vmcnt(9)
  ds_read_b64_tr_b16 v[228:229], v10 offset:2048
  ds_read_b64_tr_b16 v[230:231], v10 offset:2560
  v_exp_f32 v56, v56
  v_exp_f32 v57, v57
  s_add_u32 m0, s44, 0x400
  s_add_u32 s45, s45, 0x4000
  buffer_load_dwordx4 v9, s[12:15], s45 offen lds
  v_exp_f32 v58, v58
  v_exp_f32 v59, v59
  v_exp_f32 v28, v28
  v_exp_f32 v29, v29
  s_waitcnt lgkmcnt(4)
  v_smfmac_f32_32x32x32_bf16 v[60:75], v[24:27], v[52:59], v2
  ds_read_b128 v[24:27], v5 offset:24960
  v_exp_f32 v30, v30
  v_exp_f32 v31, v31
  v_exp_f32 v32, v32
  v_exp_f32 v33, v33
  v_exp_f32 v34, v34
  s_waitcnt lgkmcnt(4)
  v_mfma_f32_32x32x16_bf16 v[44:59], v[16:19], v[12:15], v[76:91]
  ds_read_b128 v[16:19], v1 offset:29120
  v_exp_f32 v35, v35
  v_exp_f32 v36, v36
  v_exp_f32 v37, v37
  v_exp_f32 v38, v38
  v_exp_f32 v39, v39
  s_waitcnt lgkmcnt(4)
  v_smfmac_f32_32x32x32_bf16 v[60:75], v[20:23], v[28:35], v2
  ds_read_b128 v[20:23], v4 offset:27040
  s_waitcnt vmcnt(9)
  ds_read_b64_tr_b16 v[232:233], v10 offset:3072
  ds_read_b64_tr_b16 v[234:235], v10 offset:3584
  v_exp_f32 v40, v40
  v_exp_f32 v41, v41
  s_add_u32 m0, s44, 0x800
  s_add_u32 s45, s45, 0x4000
  s_cmp_ge_u32 s45, s46
  s_cselect_b32 s7, 0x40000, 0
  s_sub_u32 s45, s45, s7
  buffer_load_dwordx4 v9, s[12:15], s45 offen lds
  v_exp_f32 v42, v42
  v_exp_f32 v43, v43
  v_exp_f32 v44, v44
  v_exp_f32 v45, v45
  s_waitcnt lgkmcnt(4)
  v_smfmac_f32_32x32x32_bf16 v[60:75], v[24:27], v[36:43], v2
  ds_read_b128 v[24:27], v5 offset:27040
  v_exp_f32 v46, v46
  v_exp_f32 v47, v47
  v_exp_f32 v48, v48
  v_exp_f32 v49, v49
  v_exp_f32 v50, v50
  s_waitcnt lgkmcnt(4)
  v_mfma_f32_32x32x16_bf16 v[28:43], v[16:19], v[12:15], v[76:91]
  ds_read_b128 v[16:19], v1 offset:31200
  v_exp_f32 v51, v51
  v_exp_f32 v52, v52
  v_exp_f32 v53, v53
  v_exp_f32 v54, v54
  v_exp_f32 v55, v55
  s_waitcnt lgkmcnt(4)
  v_smfmac_f32_32x32x32_bf16 v[60:75], v[20:23], v[44:51], v2
  ds_read_b128 v[20:23], v4 offset:29120
  s_waitcnt vmcnt(9)
  ds_read_b64_tr_b16 v[236:237], v10 offset:4096
  ds_read_b64_tr_b16 v[238:239], v10 offset:4608
  v_exp_f32 v56, v56
  v_exp_f32 v57, v57
  s_add_u32 m0, s44, 0xc00
  s_add_u32 s45, s45, 0x4000
  buffer_load_dwordx4 v9, s[12:15], s45 offen lds
  v_exp_f32 v58, v58
  v_exp_f32 v59, v59
  v_exp_f32 v28, v28
  v_exp_f32 v29, v29
  s_waitcnt lgkmcnt(4)
  v_smfmac_f32_32x32x32_bf16 v[60:75], v[24:27], v[52:59], v2
  ds_read_b128 v[24:27], v5 offset:29120
  v_exp_f32 v30, v30
  v_exp_f32 v31, v31
  v_exp_f32 v32, v32
  v_exp_f32 v33, v33
  v_exp_f32 v34, v34
  s_waitcnt lgkmcnt(4)
  v_mfma_f32_32x32x16_bf16 v[44:59], v[16:19], v[12:15], v[76:91]
  s_barrier
  ds_read_b128 v[16:19], v1 offset:33280
  v_cmp_eq_u32 vcc, s53, v252
  s_cmp_eq_u64 vcc, -1
  s_cbranch_scc0 k6_kernel_tq10
k6_kernel_tb11:
  v_exp_f32 v35, v35
  v_exp_f32 v36, v36
  v_exp_f32 v37, v37
  v_exp_f32 v38, v38
  v_exp_f32 v39, v39
  s_waitcnt lgkmcnt(4)
  v_smfmac_f32_32x32x32_bf16 v[60:75], v[20:23], v[28:35], v2
  ds_read_b128 v[20:23], v4 offset:31200
  s_waitcnt vmcnt(8)
  ds_read_b64_tr_b16 v[240:241], v10 offset:5120
  ds_read_b64_tr_b16 v[242:243], v10 offset:5632
  v_exp_f32 v40, v40
  v_exp_f32 v41, v41
  s_add_u32 m0, s44, 0x1000
  s_add_u32 s45, s45, 0x4000
  s_cmp_ge_u32 s45, s46
  s_cselect_b32 s7, 0x40000, 0
  s_sub_u32 s45, s45, s7
  buffer_load_dwordx4 v9, s[12:15], s45 offen lds
  v_exp_f32 v42, v42
  v_exp_f32 v43, v43
  v_exp_f32 v44, v44
  v_exp_f32 v45, v45
  s_waitcnt lgkmcnt(4)
  v_smfmac_f32_32x32x32_bf16 v[60:75], v[24:27], v[36:43], v2
  ds_read_b128 v[24:27], v5 offset:31200
  v_exp_f32 v46, v46
  v_exp_f32 v47, v47
  v_exp_f32 v48, v48
  v_exp_f32 v49, v49
  v_exp_f32 v50, v50
  s_waitcnt lgkmcnt(4)
  v_mfma_f32_32x32x16_bf16 v[28:43], v[16:19], v[12:15], v[76:91]
  ds_read_b128 v[16:19], v1 offset:35360
  v_exp_f32 v51, v51
  v_exp_f32 v52, v52
  v_exp_f32 v53, v53
  v_exp_f32 v54, v54
  v_exp_f32 v55, v55
  s_waitcnt lgkmcnt(4)
  v_smfmac_f32_32x32x32_bf16 v[60:75], v[20:23], v[44:51], v2
  ds_read_b128 v[20:23], v4 offset:33280
  s_waitcnt vmcnt(8)
  ds_read_b64_tr_b16 v[244:245], v10 offset:6144
  ds_read_b64_tr_b16 v[246:247], v10 offset:6656
  v_exp_f32 v56, v56
  v_exp_f32 v57, v57
  s_add_u32 m0, s44, 0x1400
  s_add_u32 s45, s45, 0x4000
  buffer_load_dwordx4 v9, s[12:15], s45 offen lds
  v_exp_f32 v58, v58
  v_exp_f32 v59, v59
  v_exp_f32 v28, v28
  v_exp_f32 v29, v29
  s_waitcnt lgkmcnt(4)
  v_smfmac_f32_32x32x32_bf16 v[60:75], v[24:27], v[52:59], v2
  ds_read_b128 v[24:27], v5 offset:33280
  v_exp_f32 v30, v30
  v_exp_f32 v31, v31
  v_exp_f32 v32, v32
  v_exp_f32 v33, v33
  v_exp_f32 v34, v34
  s_waitcnt lgkmcnt(4)
  v_mfma_f32_32x32x16_bf16 v[44:59], v[16:19], v[12:15], v[76:91]
  ds_read_b128 v[16:19], v1 offset:37440
  v_exp_f32 v35, v35
  v_exp_f32 v36, v36
  v_exp_f32 v37, v37
  v_exp_f32 v38, v38
  v_exp_f32 v39, v39
  s_waitcnt lgkmcnt(4)
  v_smfmac_f32_32x32x32_bf16 v[60:75], v[20:23], v[28:35], v2
  ds_read_b128 v[20:23], v4 offset:35360
  s_waitcnt vmcnt(7)
  ds_read_b64_tr_b16 v[248:249], v10 offset:7168
  ds_read_b64_tr_b16 v[250:251], v10 offset:7680
  v_exp_f32 v40, v40
  v_exp_f32 v41, v41
  s_add_u32 m0, s44, 0x1800
  s_add_u32 s45, s45, 0x4000
  s_cmp_ge_u32 s45, s46
  s_cselect_b32 s7, 0x40000, 0
  s_sub_u32 s45, s45, s7
  buffer_load_dwordx4 v9, s[12:15], s45 offen lds
  v_exp_f32 v42, v42
  v_exp_f32 v43, v43
  v_exp_f32 v44, v44
  v_exp_f32 v45, v45
  s_waitcnt lgkmcnt(4)
  v_smfmac_f32_32x32x32_bf16 v[60:75], v[24:27], v[36:43], v2
  ds_read_b128 v[24:27], v5 offset:35360
  v_exp_f32 v46, v46
  v_exp_f32 v47, v47
  v_exp_f32 v48, v48
  v_exp_f32 v49, v49
  v_exp_f32 v50, v50
  s_waitcnt lgkmcnt(4)
  v_mfma_f32_32x32x16_bf16 v[28:43], v[16:19], v[12:15], v[76:91]
  ds_read_b128 v[16:19], v1 offset:39520
  v_exp_f32 v51, v51
  v_exp_f32 v52, v52
  v_exp_f32 v53, v53
  v_exp_f32 v54, v54
  v_exp_f32 v55, v55
  s_waitcnt lgkmcnt(4)
  v_smfmac_f32_32x32x32_bf16 v[60:75], v[20:23], v[44:51], v2
  ds_read_b128 v[20:23], v4 offset:37440
  v_exp_f32 v56, v56
  v_exp_f32 v57, v57
  s_add_u32 m0, s44, 0x1c00
  s_add_u32 s45, s45, 0x4000
  buffer_load_dwordx4 v9, s[12:15], s45 offen lds
  v_exp_f32 v58, v58
  v_exp_f32 v59, v59
  v_exp_f32 v28, v28
  v_exp_f32 v29, v29
  s_waitcnt lgkmcnt(2)
  v_smfmac_f32_32x32x32_bf16 v[60:75], v[24:27], v[52:59], v2
  ds_read_b128 v[24:27], v5 offset:37440
  v_exp_f32 v30, v30
  v_exp_f32 v31, v31
  v_exp_f32 v32, v32
  v_exp_f32 v33, v33
  v_exp_f32 v34, v34
  s_waitcnt lgkmcnt(2)
  v_mfma_f32_32x32x16_bf16 v[44:59], v[16:19], v[12:15], v[76:91]
  ds_read_b128 v[16:19], v1 offset:41600
  v_exp_f32 v35, v35
  v_exp_f32 v36, v36
  v_exp_f32 v37, v37
  v_exp_f32 v38, v38
  v_exp_f32 v39, v39
  s_waitcnt lgkmcnt(2)
  v_smfmac_f32_32x32x32_bf16 v[60:75], v[20:23], v[28:35], v2
  ds_read_b128 v[20:23], v4 offset:39520
  v_exp_f32 v40, v40
  v_exp_f32 v41, v41
  v_exp_f32 v42, v42
  v_exp_f32 v43, v43
  v_exp_f32 v44, v44
  v_exp_f32 v45, v45
  s_waitcnt lgkmcnt(2)
  v_smfmac_f32_32x32x32_bf16 v[60:75], v[24:27], v[36:43], v2
  ds_read_b128 v[24:27], v5 offset:39520
  v_exp_f32 v46, v46
  v_exp_f32 v47, v47
  v_exp_f32 v48, v48
  v_exp_f32 v49, v49
  v_exp_f32 v50, v50
  s_waitcnt lgkmcnt(2)
  v_mfma_f32_32x32x16_bf16 v[28:43], v[16:19], v[12:15], v[76:91]
  ds_read_b128 v[16:19], v1 offset:43680
  v_lshlrev_b32 v253, 2, v1
  s_add_u32 s65, s65, 0x1000
  buffer_load_dword v254, v253, s[20:23], s65 offen
  v_exp_f32 v51, v51
  v_exp_f32 v52, v52
  v_exp_f32 v53, v53
  v_exp_f32 v54, v54
  v_exp_f32 v55, v55
  s_waitcnt lgkmcnt(2)
  v_smfmac_f32_32x32x32_bf16 v[60:75], v[20:23], v[44:51], v2
  ds_read_b128 v[20:23], v4 offset:41600
  v_exp_f32 v56, v56
  v_exp_f32 v57, v57
  v_exp_f32 v58, v58
  v_exp_f32 v59, v59
  v_exp_f32 v28, v28
  v_exp_f32 v29, v29
  s_waitcnt lgkmcnt(2)
  v_smfmac_f32_32x32x32_bf16 v[60:75], v[24:27], v[52:59], v2
  ds_read_b128 v[24:27], v5 offset:41600
  v_exp_f32 v30, v30
  v_exp_f32 v31, v31
  v_exp_f32 v32, v32
  v_exp_f32 v33, v33
  v_exp_f32 v34, v34
  s_waitcnt lgkmcnt(2)
  v_mfma_f32_32x32x16_bf16 v[44:59], v[16:19], v[12:15], v[76:91]
  ds_read_b128 v[16:19], v1 offset:45760
  v_exp_f32 v35, v35
  v_exp_f32 v36, v36
  v_exp_f32 v37, v37
  v_exp_f32 v38, v38
  v_exp_f32 v39, v39
  s_waitcnt lgkmcnt(2)
  v_smfmac_f32_32x32x32_bf16 v[60:75], v[20:23], v[28:35], v2
  ds_read_b128 v[20:23], v4 offset:43680
  v_exp_f32 v40, v40
  v_exp_f32 v41, v41
  v_exp_f32 v42, v42
  v_exp_f32 v43, v43
  v_exp_f32 v44, v44
  v_exp_f32 v45, v45
  s_waitcnt lgkmcnt(2)
  v_smfmac_f32_32x32x32_bf16 v[60:75], v[24:27], v[36:43], v2
  ds_read_b128 v[24:27], v5 offset:43680
  v_exp_f32 v46, v46
  v_exp_f32 v47, v47
  v_exp_f32 v48, v48
  v_exp_f32 v49, v49
  v_exp_f32 v50, v50
  s_waitcnt lgkmcnt(2)
  v_mfma_f32_32x32x16_bf16 v[28:43], v[16:19], v[12:15], v[76:91]
  ds_read_b128 v[16:19], v1 offset:47840
  v_exp_f32 v51, v51
  v_exp_f32 v52, v52
  v_exp_f32 v53, v53
  v_exp_f32 v54, v54
  v_exp_f32 v55, v55
  s_waitcnt lgkmcnt(2)
  v_smfmac_f32_32x32x32_bf16 v[60:75], v[20:23], v[44:51], v2
  ds_read_b128 v[20:23], v4 offset:45760
  v_exp_f32 v56, v56
  v_exp_f32 v57, v57
  buffer_load_dword v252, v11, s[32:35], 0 offen
  v_exp_f32 v58, v58
  v_exp_f32 v59, v59
  v_exp_f32 v28, v28
  v_exp_f32 v29, v29
  s_waitcnt lgkmcnt(2)
  v_smfmac_f32_32x32x32_bf16 v[60:75], v[24:27], v[52:59], v2
  ds_read_b128 v[24:27], v5 offset:45760
  v_exp_f32 v30, v30
  v_exp_f32 v31, v31
  v_exp_f32 v32, v32
  v_exp_f32 v33, v33
  v_exp_f32 v34, v34
  s_waitcnt lgkmcnt(2)
  v_mfma_f32_32x32x16_bf16 v[44:59], v[16:19], v[12:15], v[76:91]
  s_barrier
  ds_read_b128 v[16:19], v1 offset:49920
  v_exp_f32 v35, v35
  v_exp_f32 v36, v36
  v_exp_f32 v37, v37
  v_exp_f32 v38, v38
  v_exp_f32 v39, v39
  s_waitcnt lgkmcnt(2)
  v_smfmac_f32_32x32x32_bf16 v[60:75], v[20:23], v[28:35], v2
  ds_read_b128 v[20:23], v4 offset:47840
  v_exp_f32 v40, v40
  v_exp_f32 v41, v41
  v_exp_f32 v42, v42
  v_exp_f32 v43, v43
  v_exp_f32 v44, v44
  v_exp_f32 v45, v45
  s_waitcnt lgkmcnt(2)
  v_smfmac_f32_32x32x32_bf16 v[60:75], v[24:27], v[36:43], v2
  ds_read_b128 v[24:27], v5 offset:47840
  v_exp_f32 v46, v46
  v_exp_f32 v47, v47
  v_exp_f32 v48, v48
  v_exp_f32 v49, v49
  v_exp_f32 v50, v50
  s_waitcnt lgkmcnt(2)
  v_mfma_f32_32x32x16_bf16 v[28:43], v[16:19], v[12:15], v[76:91]
  ds_read_b128 v[16:19], v1 offset:52000
  v_exp_f32 v51, v51
  v_exp_f32 v52, v52
  v_exp_f32 v53, v53
  v_exp_f32 v54, v54
  v_exp_f32 v55, v55
  s_waitcnt lgkmcnt(2)
  v_smfmac_f32_32x32x32_bf16 v[60:75], v[20:23], v[44:51], v2
  ds_read_b128 v[20:23], v4 offset:49920
  v_exp_f32 v56, v56
  v_exp_f32 v57, v57
  v_exp_f32 v58, v58
  v_exp_f32 v59, v59
  v_exp_f32 v28, v28
  v_exp_f32 v29, v29
  s_waitcnt lgkmcnt(2)
  v_smfmac_f32_32x32x32_bf16 v[60:75], v[24:27], v[52:59], v2
  ds_read_b128 v[24:27], v5 offset:49920
  v_exp_f32 v30, v30
  v_exp_f32 v31, v31
  v_exp_f32 v32, v32
  v_exp_f32 v33, v33
  v_exp_f32 v34, v34
  s_waitcnt lgkmcnt(2)
  v_mfma_f32_32x32x16_bf16 v[44:59], v[16:19], v[12:15], v[76:91]
  ds_read_b128 v[16:19], v1 offset:54080
  v_exp_f32 v35, v35
  v_exp_f32 v36, v36
  v_exp_f32 v37, v37
  v_exp_f32 v38, v38
  v_exp_f32 v39, v39
  s_waitcnt lgkmcnt(2)
  v_smfmac_f32_32x32x32_bf16 v[60:75], v[20:23], v[28:35], v2
  ds_read_b128 v[20:23], v4 offset:52000
  v_exp_f32 v40, v40
  v_exp_f32 v41, v41
  v_exp_f32 v42, v42
  v_exp_f32 v43, v43
  v_exp_f32 v44, v44
  v_exp_f32 v45, v45
  s_waitcnt lgkmcnt(2)
  v_smfmac_f32_32x32x32_bf16 v[60:75], v[24:27], v[36:43], v2
  ds_read_b128 v[24:27], v5 offset:52000
  v_exp_f32 v46, v46
  v_exp_f32 v47, v47
  v_exp_f32 v48, v48
  v_exp_f32 v49, v49
  v_exp_f32 v50, v50
  s_waitcnt lgkmcnt(2)
  v_mfma_f32_32x32x16_bf16 v[28:43], v[16:19], v[12:15], v[76:91]
  ds_read_b128 v[16:19], v1 offset:56160
  v_exp_f32 v51, v51
  v_exp_f32 v52, v52
  v_exp_f32 v53, v53
  v_exp_f32 v54, v54
  v_exp_f32 v55, v55
  s_waitcnt lgkmcnt(2)
  v_smfmac_f32_32x32x32_bf16 v[60:75], v[20:23], v[44:51], v2
  ds_read_b128 v[20:23], v4 offset:54080
  v_exp_f32 v56, v56
  v_exp_f32 v57, v57
  v_lshrrev_b32 v8, 6, v1
  v_and_b32 v8, 8, v8
  v_lshl_add_u32 v8, v255, 8, v8
  buffer_load_dwordx2 v[252:253], v8, s[24:27], s64 offen
  buffer_load_dwordx2 v[254:255], v8, s[24:27], s64 offen offset:16
  v_exp_f32 v58, v58
  v_exp_f32 v59, v59
  v_exp_f32 v28, v28
  v_exp_f32 v29, v29
  s_waitcnt lgkmcnt(2)
  v_smfmac_f32_32x32x32_bf16 v[60:75], v[24:27], v[52:59], v2
  ds_read_b128 v[24:27], v5 offset:54080
  v_exp_f32 v30, v30
  v_exp_f32 v31, v31
  v_exp_f32 v32, v32
  v_exp_f32 v33, v33
  v_exp_f32 v34, v34
  s_waitcnt lgkmcnt(2)
  v_mfma_f32_32x32x16_bf16 v[44:59], v[16:19], v[12:15], v[76:91]
  ds_read_b128 v[16:19], v1 offset:58240
  v_exp_f32 v35, v35
  v_exp_f32 v36, v36
  v_exp_f32 v37, v37
  v_exp_f32 v38, v38
  v_exp_f32 v39, v39
  s_waitcnt lgkmcnt(2)
  v_smfmac_f32_32x32x32_bf16 v[60:75], v[20:23], v[28:35], v2
  ds_read_b128 v[20:23], v4 offset:56160
  v_exp_f32 v40, v40
  v_exp_f32 v41, v41
  v_exp_f32 v42, v42
  v_exp_f32 v43, v43
  v_exp_f32 v44, v44
  v_exp_f32 v45, v45
  s_waitcnt lgkmcnt(2)
  v_smfmac_f32_32x32x32_bf16 v[60:75], v[24:27], v[36:43], v2
  ds_read_b128 v[24:27], v5 offset:56160
  v_exp_f32 v46, v46
  v_exp_f32 v47, v47
  v_exp_f32 v48, v48
  v_exp_f32 v49, v49
  v_exp_f32 v50, v50
  s_waitcnt lgkmcnt(2)
  v_mfma_f32_32x32x16_bf16 v[28:43], v[16:19], v[12:15], v[76:91]
  ds_read_b128 v[16:19], v1 offset:60320
  v_exp_f32 v51, v51
  v_exp_f32 v52, v52
  v_exp_f32 v53, v53
  v_exp_f32 v54, v54
  v_exp_f32 v55, v55
  s_waitcnt lgkmcnt(2)
  v_smfmac_f32_32x32x32_bf16 v[60:75], v[20:23], v[44:51], v2
  ds_read_b128 v[20:23], v4 offset:58240
  v_exp_f32 v56, v56
  v_exp_f32 v57, v57
  v_exp_f32 v58, v58
  v_exp_f32 v59, v59
  v_exp_f32 v28, v28
  v_exp_f32 v29, v29
  s_waitcnt lgkmcnt(2)
  v_smfmac_f32_32x32x32_bf16 v[60:75], v[24:27], v[52:59], v2
  ds_read_b128 v[24:27], v5 offset:58240
  v_exp_f32 v30, v30
  v_exp_f32 v31, v31
  v_exp_f32 v32, v32
  v_exp_f32 v33, v33
  v_exp_f32 v34, v34
  s_waitcnt lgkmcnt(2)
  v_mfma_f32_32x32x16_bf16 v[44:59], v[16:19], v[12:15], v[76:91]
  ds_read_b128 v[16:19], v1 offset:62400
  v_exp_f32 v35, v35
  v_exp_f32 v36, v36
  v_exp_f32 v37, v37
  v_exp_f32 v38, v38
  v_exp_f32 v39, v39
  s_waitcnt lgkmcnt(2)
  v_smfmac_f32_32x32x32_bf16 v[60:75], v[20:23], v[28:35], v2
  ds_read_b128 v[20:23], v4 offset:60320
  v_exp_f32 v40, v40
  v_exp_f32 v41, v41
  v_exp_f32 v42, v42
  v_exp_f32 v43, v43
  v_exp_f32 v44, v44
  v_exp_f32 v45, v45
  s_waitcnt lgkmcnt(2)
  v_smfmac_f32_32x32x32_bf16 v[60:75], v[24:27], v[36:43], v2
  ds_read_b128 v[24:27], v5 offset:60320
  v_exp_f32 v46, v46
  v_exp_f32 v47, v47
  v_exp_f32 v48, v48
  v_exp_f32 v49, v49
  v_exp_f32 v50, v50
  s_waitcnt lgkmcnt(2)
  v_mfma_f32_32x32x16_bf16 v[28:43], v[16:19], v[12:15], v[76:91]
  ds_read_b128 v[16:19], v1 offset:64480
  v_exp_f32 v51, v51
  v_exp_f32 v52, v52
  v_exp_f32 v53, v53
  v_exp_f32 v54, v54
  v_exp_f32 v55, v55
  s_waitcnt lgkmcnt(2)
  v_smfmac_f32_32x32x32_bf16 v[60:75], v[20:23], v[44:51], v2
  ds_read_b128 v[20:23], v4 offset:62400
  v_exp_f32 v56, v56
  v_exp_f32 v57, v57
  v_exp_f32 v58, v58
  v_exp_f32 v59, v59
  v_exp_f32 v28, v28
  v_exp_f32 v29, v29
  s_waitcnt lgkmcnt(2)
  v_smfmac_f32_32x32x32_bf16 v[60:75], v[24:27], v[52:59], v2
  ds_read_b128 v[24:27], v5 offset:62400
  v_exp_f32 v30, v30
  v_exp_f32 v31, v31
  v_exp_f32 v32, v32
  v_exp_f32 v33, v33
  v_exp_f32 v34, v34
  s_waitcnt lgkmcnt(2)
  v_mfma_f32_32x32x16_bf16 v[44:59], v[16:19], v[12:15], v[76:91]
  v_exp_f32 v35, v35
  v_exp_f32 v36, v36
  v_exp_f32 v37, v37
  v_exp_f32 v38, v38
  v_exp_f32 v39, v39
  s_waitcnt lgkmcnt(1)
  v_smfmac_f32_32x32x32_bf16 v[60:75], v[20:23], v[28:35], v2
  ds_read_b128 v[20:23], v4 offset:64480
  v_exp_f32 v40, v40
  v_exp_f32 v41, v41
  v_exp_f32 v42, v42
  v_exp_f32 v43, v43
  v_exp_f32 v44, v44
  v_exp_f32 v45, v45
  s_waitcnt lgkmcnt(1)
  v_smfmac_f32_32x32x32_bf16 v[60:75], v[24:27], v[36:43], v2
  ds_read_b128 v[24:27], v5 offset:64480
  v_exp_f32 v46, v46
  v_exp_f32 v47, v47
  v_exp_f32 v48, v48
  v_exp_f32 v49, v49
  v_exp_f32 v50, v50
  v_exp_f32 v51, v51
  v_exp_f32 v52, v52
  v_exp_f32 v53, v53
  v_exp_f32 v54, v54
  v_exp_f32 v55, v55
  s_waitcnt lgkmcnt(1)
  v_smfmac_f32_32x32x32_bf16 v[60:75], v[20:23], v[44:51], v2
  v_exp_f32 v56, v56
  v_exp_f32 v57, v57
  v_exp_f32 v58, v58
  v_exp_f32 v59, v59
  v_mov_b32 v0, 0x5d800000
  s_waitcnt lgkmcnt(0)
  v_smfmac_f32_32x32x32_bf16 v[60:75], v[24:27], v[52:59], v2
  s_nop 11
  v_mov_b32 v76, v68
  v_fmac_f32 v76, 0, v60
  v_fmac_f32 v76, 0, v61
  v_fmac_f32 v76, 0, v62
  v_fmac_f32 v76, 0, v63
  v_fmac_f32 v76, 0, v64
  v_fmac_f32 v76, 0, v65
  v_fmac_f32 v76, 0, v66
  v_fmac_f32 v76, 0, v67
  v_cmp_gt_f32 vcc, v0, v76
  s_cmp_eq_u64 vcc, -1
  s_cbranch_scc0 k6_kernel_fb13
k6_kernel_epi12:
  s_nop 8
  v_rcp_f32 v76, v68
  s_nop 0
  v_mul_f32 v60, v60, v76
  v_mul_f32 v61, v61, v76
  v_mul_f32 v62, v62, v76
  v_mul_f32 v63, v63, v76
  v_mul_f32 v64, v64, v76
  v_mul_f32 v65, v65, v76
  v_mul_f32 v66, v66, v76
  v_mul_f32 v67, v67, v76
  v_cvt_pk_bf16_f32 v80, v60, v61
  v_cvt_pk_bf16_f32 v81, v62, v63
  v_cvt_pk_bf16_f32 v82, v64, v65
  v_cvt_pk_bf16_f32 v83, v66, v67
  buffer_store_dwordx4 v[80:83], v1, s[8:11], s54 offen sc1
  s_waitcnt vmcnt(13)
  ds_read_b64_tr_b16 v[28:29], v10 offset:0
  ds_read_b64_tr_b16 v[30:31], v10 offset:512
  s_waitcnt vmcnt(11)
  ds_read_b64_tr_b16 v[32:33], v10 offset:1024
  ds_read_b64_tr_b16 v[34:35], v10 offset:1536
  s_waitcnt vmcnt(10)
  ds_read_b64_tr_b16 v[36:37], v10 offset:2048
  ds_read_b64_tr_b16 v[38:39], v10 offset:2560
  s_waitcnt vmcnt(9)
  ds_read_b64_tr_b16 v[40:41], v10 offset:3072
  ds_read_b64_tr_b16 v[42:43], v10 offset:3584
  s_waitcnt vmcnt(8)
  ds_read_b64_tr_b16 v[44:45], v10 offset:4096
  ds_read_b64_tr_b16 v[46:47], v10 offset:4608
  s_waitcnt vmcnt(7)
  ds_read_b64_tr_b16 v[48:49], v10 offset:5120
  ds_read_b64_tr_b16 v[50:51], v10 offset:5632
  s_waitcnt vmcnt(6)
  ds_read_b64_tr_b16 v[52:53], v10 offset:6144
  ds_read_b64_tr_b16 v[54:55], v10 offset:6656
  s_waitcnt vmcnt(5)
  ds_read_b64_tr_b16 v[56:57], v10 offset:7168
  ds_read_b64_tr_b16 v[58:59], v10 offset:7680
  v_lshrrev_b32 v84, 4, v1
  v_bfe_u32 v85, v84, 2, 1
  v_bfe_u32 v86, v84, 4, 1
  v_cmp_eq_u32 vcc, v85, v86
  v_mov_b32 v85, 0x3f803f80
  s_nop 0
  v_cndmask_b32 v12, 0, v85, vcc
  v_mov_b32 v13, v12
  v_mov_b32 v14, v12
  v_mov_b32 v15, v12
  v_and_b32 v9, 31, v84
  v_lshlrev_b32 v9, 2, v9
  v_lshlrev_b32 v86, 6, v86
  v_and_b32 v3, 0x70, v1
  v_xor_b32 v3, v3, v86
  v_lshrrev_b32 v85, 3, v84
  v_lshl_add_u32 v3, v85, 10, v3
  v_add_u32 v11, 0x1c00, v3
  v_mfma_f32_16x16x32_bf16 v[16:19], v[12:15], v[124:127], 0
  v_mfma_f32_16x16x32_bf16 v[16:19], v[12:15], v[128:131], v[16:19]
  v_mfma_f32_16x16x32_bf16 v[16:19], v[12:15], v[132:135], v[16:19]
  v_mfma_f32_16x16x32_bf16 v[16:19], v[12:15], v[136:139], v[16:19]
  v_mfma_f32_16x16x32_bf16 v[16:19], v[12:15], v[140:143], v[16:19]
  v_mfma_f32_16x16x32_bf16 v[16:19], v[12:15], v[144:147], v[16:19]
  v_mfma_f32_16x16x32_bf16 v[16:19], v[12:15], v[148:151], v[16:19]
  v_mfma_f32_16x16x32_bf16 v[16:19], v[12:15], v[152:155], v[16:19]
  v_and_b32 v89, 28, v84
  v_lshlrev_b32 v89, 5, v89
  v_and_b32 v85, 3, v84
  v_lshl_add_u32 v89, v85, 2, v89
  s_waitcnt vmcnt(0)
  s_mov_b64 exec, 1
  buffer_store_dword v2, off, s[8:11], s58 sc1
  s_mov_b64 exec, -1
  s_cmp_lg_u32 s6, 0
  s_cbranch_scc1 k6_kernel_nw014
  buffer_load_dword v88, v89, s[8:11], s59 offen sc1
k6_kernel_nw014:
  v_mfma_f32_16x16x32_bf16 v[16:19], v[12:15], v[156:159], v[16:19]
  v_lshrrev_b32 v87, 5, v84
  v_bfe_u32 v85, v84, 2, 2
  v_mfma_f32_16x16x32_bf16 v[16:19], v[12:15], v[160:163], v[16:19]
  v_lshl_add_u32 v85, v87, 2, v85
  v_lshlrev_b32 v85, 7, v85
  v_mfma_f32_16x16x32_bf16 v[16:19], v[12:15], v[164:167], v[16:19]
  v_bfe_u32 v86, v84, 3, 1
  v_lshl_add_u32 v85, v86, 6, v85
  v_mfma_f32_16x16x32_bf16 v[16:19], v[12:15], v[168:171], v[16:19]
  v_bfe_u32 v86, v84, 4, 1
  v_lshl_add_u32 v85, v86, 5, v85
  v_mfma_f32_16x16x32_bf16 v[16:19], v[12:15], v[172:175], v[16:19]
  v_and_b32 v86, 3, v84
  v_lshl_add_u32 v85, v86, 3, v85
  v_mfma_f32_16x16x32_bf16 v[16:19], v[12:15], v[176:179], v[16:19]
  v_add_u32 v4, s44, v85
  v_xor_b32 v85, 64, v85
  v_mfma_f32_16x16x32_bf16 v[16:19], v[12:15], v[180:183], v[16:19]
  v_add_u32 v5, s44, v85
  s_lshr_b32 s7, s6, 2
  v_mfma_f32_16x16x32_bf16 v[16:19], v[12:15], v[184:187], v[16:19]
  s_lshl_b32 s7, s7, 14
  v_add_u32 v6, s7, v1
  v_mfma_f32_16x16x32_bf16 v[16:19], v[12:15], v[188:191], v[16:19]
  s_lshl_b32 s7, s6, 11
  s_add_u32 s7, s7, 0x10000
  v_mfma_f32_16x16x32_bf16 v[16:19], v[12:15], v[192:195], v[16:19]
  v_add_u32 v7, s7, v1
  v_xor_b32 v8, 0x2000, v7
  v_mfma_f32_16x16x32_bf16 v[16:19], v[12:15], v[196:199], v[16:19]
  v_and_b32 v0, 7, v84
  v_min_u32 v0, 6, v0
  v_mfma_f32_16x16x32_bf16 v[16:19], v[12:15], v[200:203], v[16:19]
  v_lshlrev_b32 v0, 2, v0
  s_and_b32 s7, s6, 3
  v_mfma_f32_16x16x32_bf16 v[16:19], v[12:15], v[204:207], v[16:19]
  s_lshl_b32 s7, s7, 1
  s_add_u32 s7, s7, s68
  v_mfma_f32_16x16x32_bf16 v[16:19], v[12:15], v[208:211], v[16:19]
  s_add_u32 s36, s7, 1
  s_and_b32 s7, s7, 7
  v_mfma_f32_16x16x32_bf16 v[16:19], v[12:15], v[212:215], v[16:19]
  s_and_b32 s36, s36, 7
  s_lshl_b32 s70, s7, 11
  v_mfma_f32_16x16x32_bf16 v[16:19], v[12:15], v[216:219], v[16:19]
  s_lshl_b32 s71, s36, 11
  s_lshr_b32 s7, s6, 2
  v_mfma_f32_16x16x32_bf16 v[16:19], v[12:15], v[220:223], v[16:19]
  s_lshl_b32 s7, s7, 14
  s_lshl_b32 s36, s37, 3
  v_mfma_f32_16x16x32_bf16 v[16:19], v[12:15], v[224:227], v[16:19]
  s_add_u32 s36, s36, s68
  s_lshl_b32 s36, s36, 15
  v_mfma_f32_16x16x32_bf16 v[16:19], v[12:15], v[228:231], v[16:19]
  s_add_u32 s7, s7, s36
  s_add_u32 s7, s7, 0x600000
  v_mfma_f32_16x16x32_bf16 v[16:19], v[12:15], v[232:235], v[16:19]
  s_add_u32 s70, s70, s7
  s_add_u32 s71, s71, s7
  v_mfma_f32_16x16x32_bf16 v[16:19], v[12:15], v[236:239], v[16:19]
  s_lshl_b32 s43, s6, 12
  v_mfma_f32_16x16x32_bf16 v[16:19], v[12:15], v[240:243], v[16:19]
  v_mfma_f32_16x16x32_bf16 v[16:19], v[12:15], v[244:247], v[16:19]
  v_mfma_f32_16x16x32_bf16 v[16:19], v[12:15], v[248:251], v[16:19]
  s_waitcnt lgkmcnt(0)
  v_lshlrev_b32 v10, 2, v84
  s_nop 5
  v_cvt_pk_bf16_f32 v12, v16, v16
  v_and_b32 v85, 0xffff0000, v12
  v_sub_f32 v85, v16, v85
  v_cvt_pk_bf16_f32 v13, v85, v85
  v_mov_b32 v16, 0
  v_mov_b32 v17, 0
  s_cmp_lg_u32 s6, 0
  s_cbranch_scc1 k6_kernel_nw015
  s_waitcnt vmcnt(0)
  v_cmp_eq_u32 vcc, s51, v88
  s_cmp_eq_u64 vcc, -1
  s_cbranch_scc0 k6_kernel_pq16
k6_kernel_pr17:
k6_kernel_nw015:
  s_barrier
  s_add_u32 m0, s43, 0
  s_nop 0
  buffer_load_dwordx4 v1, s[8:11], s70 offen  lds
  buffer_load_dwordx4 v1, s[8:11], s70 offen offset:1024  lds
  s_add_u32 m0, s43, 0x800
  s_nop 0
  buffer_load_dwordx4 v1, s[8:11], s71 offen  lds
  buffer_load_dwordx4 v1, s[8:11], s71 offen offset:1024  lds
  s_lshr_b32 s7, s75, 1
  s_and_b32 s7, s7, 0xffff8000
  s_lshl_b32 s7, s7, 1
  s_lshl_b32 s43, s6, 10
  s_add_u32 s7, s7, s43
  s_add_u32 s7, s7, 0x800000
  s_add_u32 s36, s66, 0
  s_and_b32 s36, s36, 3
  s_lshl_b32 s36, s36, 13
  s_add_u32 s70, s7, s36
  s_add_u32 s36, s66, 1
  s_and_b32 s36, s36, 3
  s_lshl_b32 s36, s36, 13
  s_add_u32 s71, s7, s36
  s_add_u32 s36, s66, 2
  s_and_b32 s36, s36, 3
  s_lshl_b32 s36, s36, 13
  s_add_u32 s72, s7, s36
  s_add_u32 s36, s66, 3
  s_and_b32 s36, s36, 3
  s_lshl_b32 s36, s36, 13
  s_add_u32 s73, s7, s36
  s_add_u32 m0, s44, 0
  s_nop 0
  buffer_load_dwordx4 v3, s[20:23], s69 offen lds
  s_add_u32 m0, s44, 0
  s_nop 0
  buffer_load_dwordx4 v11, s[20:23], s69 offen offset:1024 lds
  s_waitcnt vmcnt(2)
  s_barrier
  ds_read_b128 v[76:79], v6 offset:0
  ds_read_b128 v[80:83], v6 offset:1024
  ds_read_b128 v[84:87], v6 offset:2048
  ds_read_b128 v[88:91], v6 offset:3072
  s_waitcnt lgkmcnt(3)
  v_mfma_f32_32x32x16_bf16 v[60:75], v[92:95], v[76:79], 0
  ds_read_b128 v[76:79], v6 offset:4096
  s_waitcnt lgkmcnt(3)
  v_mfma_f32_32x32x16_bf16 v[60:75], v[96:99], v[80:83], v[60:75]
  ds_read_b128 v[80:83], v6 offset:5120
  s_add_u32 m0, s44, 0x800
  s_add_u32 s69, s69, 0x4000
  buffer_load_dwordx4 v3, s[20:23], s69 offen lds
  s_waitcnt lgkmcnt(3)
  v_mfma_f32_32x32x16_bf16 v[60:75], v[100:103], v[84:87], v[60:75]
  ds_read_b128 v[84:87], v6 offset:6144
  s_waitcnt lgkmcnt(3)
  v_mfma_f32_32x32x16_bf16 v[60:75], v[104:107], v[88:91], v[60:75]
  ds_read_b128 v[88:91], v6 offset:7168
  s_add_u32 m0, s44, 0x800
  s_nop 0
  buffer_load_dwordx4 v11, s[20:23], s69 offen offset:1024 lds
  s_waitcnt lgkmcnt(3)
  v_mfma_f32_32x32x16_bf16 v[60:75], v[108:111], v[76:79], v[60:75]
  ds_read_b128 v[76:79], v6 offset:8192
  s_waitcnt lgkmcnt(3)
  v_mfma_f32_32x32x16_bf16 v[60:75], v[112:115], v[80:83], v[60:75]
  ds_read_b128 v[80:83], v6 offset:9216
  s_add_u32 m0, s44, 0x1000
  s_add_u32 s69, s69, 0x4000
  buffer_load_dwordx4 v3, s[20:23], s69 offen lds
  s_waitcnt lgkmcnt(3)
  v_mfma_f32_32x32x16_bf16 v[60:75], v[116:119], v[84:87], v[60:75]
  ds_read_b128 v[84:87], v6 offset:10240
  s_waitcnt lgkmcnt(3)
  v_mfma_f32_32x32x16_bf16 v[60:75], v[120:123], v[88:91], v[60:75]
  ds_read_b128 v[88:91], v6 offset:11264
  s_add_u32 m0, s44, 0x1000
  s_nop 0
  buffer_load_dwordx4 v11, s[20:23], s69 offen offset:1024 lds
  s_waitcnt lgkmcnt(3)
  v_mfma_f32_32x32x16_bf16 v[60:75], v[28:31], v[76:79], v[60:75]
  ds_read_b128 v[76:79], v6 offset:12288
  s_waitcnt lgkmcnt(3)
  v_mfma_f32_32x32x16_bf16 v[60:75], v[32:35], v[80:83], v[60:75]
  ds_read_b128 v[80:83], v6 offset:13312
  s_add_u32 m0, s44, 0x1800
  s_add_u32 s69, s69, 0x4000
  buffer_load_dwordx4 v3, s[20:23], s69 offen lds
  s_waitcnt lgkmcnt(3)
  v_mfma_f32_32x32x16_bf16 v[60:75], v[36:39], v[84:87], v[60:75]
  ds_read_b128 v[84:87], v6 offset:14336
  s_waitcnt lgkmcnt(3)
  v_mfma_f32_32x32x16_bf16 v[60:75], v[40:43], v[88:91], v[60:75]
  ds_read_b128 v[88:91], v6 offset:15360
  s_add_u32 m0, s44, 0x1800
  s_nop 0
  buffer_load_dwordx4 v11, s[20:23], s69 offen offset:1024 lds
  s_waitcnt lgkmcnt(3)
  v_mfma_f32_32x32x16_bf16 v[60:75], v[44:47], v[76:79], v[60:75]
  v_lshlrev_b32 v18, 16, v252
  v_and_b32 v19, 0xffff0000, v252
  s_waitcnt lgkmcnt(2)
  v_mfma_f32_32x32x16_bf16 v[60:75], v[48:51], v[80:83], v[60:75]
  v_lshlrev_b32 v20, 16, v253
  v_and_b32 v21, 0xffff0000, v253
  s_waitcnt lgkmcnt(1)
  v_mfma_f32_32x32x16_bf16 v[60:75], v[52:55], v[84:87], v[60:75]
  v_lshlrev_b32 v22, 16, v254
  v_and_b32 v23, 0xffff0000, v254
  s_waitcnt lgkmcnt(0)
  v_mfma_f32_32x32x16_bf16 v[60:75], v[56:59], v[88:91], v[60:75]
  v_lshlrev_b32 v24, 16, v255
  v_and_b32 v25, 0xffff0000, v255
  s_nop 9
  ds_write_b128 v7, v[68:71]
  ds_write_b128 v7, v[72:75] offset:1024
  v_add_f32 v60, v60, v18
  v_add_f32 v61, v61, v19
  v_add_f32 v62, v62, v20
  v_add_f32 v63, v63, v21
  v_add_f32 v64, v64, v22
  v_add_f32 v65, v65, v23
  v_add_f32 v66, v66, v24
  v_add_f32 v67, v67, v25
  s_waitcnt lgkmcnt(0)
  s_barrier
  ds_read_b128 v[76:79], v8
  ds_read_b128 v[80:83], v8 offset:1024
  s_waitcnt lgkmcnt(1)
  v_add_f32 v60, v60, v76
  v_add_f32 v61, v61, v77
  v_add_f32 v62, v62, v78
  v_add_f32 v63, v63, v79
  s_waitcnt lgkmcnt(0)
  v_add_f32 v64, v64, v80
  v_add_f32 v65, v65, v81
  v_add_f32 v66, v66, v82
  v_add_f32 v67, v67, v83
  v_cvt_pk_bf16_f32 v84, v60, v61
  v_cvt_pk_bf16_f32 v85, v62, v63
  v_cvt_pk_bf16_f32 v86, v64, v65
  v_cvt_pk_bf16_f32 v87, v66, v67
  buffer_store_dwordx4 v[84:87], v1, s[8:11], s55 offen
  s_cmp_eq_u32 s6, 7
  s_cbranch_scc1 k6_kernel_w718
  s_waitcnt vmcnt(7)
  ds_read_b64_tr_b16 v[92:93], v4 offset:0
  ds_read_b64_tr_b16 v[94:95], v4 offset:1024
  ds_read_b64_tr_b16 v[96:97], v5 offset:0
  ds_read_b64_tr_b16 v[98:99], v5 offset:1024
  s_waitcnt vmcnt(5)
  ds_read_b64_tr_b16 v[100:101], v4 offset:2048
  ds_read_b64_tr_b16 v[102:103], v4 offset:3072
  ds_read_b64_tr_b16 v[104:105], v5 offset:2048
  ds_read_b64_tr_b16 v[106:107], v5 offset:3072
  s_waitcnt vmcnt(3)
  ds_read_b64_tr_b16 v[108:109], v4 offset:4096
  ds_read_b64_tr_b16 v[110:111], v4 offset:5120
  ds_read_b64_tr_b16 v[112:113], v5 offset:4096
  ds_read_b64_tr_b16 v[114:115], v5 offset:5120
  s_waitcnt vmcnt(1)
  ds_read_b64_tr_b16 v[116:117], v4 offset:6144
  ds_read_b64_tr_b16 v[118:119], v4 offset:7168
  ds_read_b64_tr_b16 v[120:121], v5 offset:6144
  ds_read_b64_tr_b16 v[122:123], v5 offset:7168
  v_lshrrev_b32 v76, 4, v1
  v_add_u32 v6, 0x24d00, v9
  v_lshrrev_b32 v77, 5, v76
  v_mul_u32_u24 v77, 0x210, v77
  v_and_b32 v78, 0x1f0, v1
  v_add_u32 v77, v77, v78
  s_sub_u32 s7, s44, 0x14500
  v_add_u32 v7, s7, v77
  v_and_b32 v77, 15, v76
  v_lshrrev_b32 v78, 4, v76
  s_lshl_b32 s7, s6, 2
  v_add_u32 v78, s7, v78
  v_mul_u32_u24 v8, 0x210, v77
  v_lshl_add_u32 v8, v78, 4, v8
  v_lshlrev_b32 v9, 3, v77
  v_lshl_add_u32 v9, v78, 10, v9
  s_waitcnt vmcnt(0)
  s_cmp_lg_u32 s52, 0
  s_mov_b64 exec, 1
  s_cbranch_scc1 k6_kernel_pub19
  buffer_store_dword v2, off, s[8:11], s60
k6_kernel_pb20:
  s_mov_b64 exec, -1
  buffer_load_dword v79, v10, s[8:11], s61 offen sc1
  s_waitcnt vmcnt(0)
  v_cmp_eq_u32 vcc, s51, v79
  s_cmp_eq_u64 vcc, -1
  s_cbranch_scc0 k6_kernel_pq21
k6_kernel_pr22:
  s_add_u32 m0, s43, 0
  s_nop 0
  buffer_load_dwordx4 v1, s[8:11], s70 offen sc1 lds
  s_add_u32 m0, s43, 0x2000
  s_nop 0
  buffer_load_dwordx4 v1, s[8:11], s71 offen sc1 lds
  s_add_u32 m0, s43, 0x4000
  s_nop 0
  buffer_load_dwordx4 v1, s[8:11], s72 offen sc1 lds
  s_add_u32 m0, s43, 0x6000
  s_nop 0
  buffer_load_dwordx4 v1, s[8:11], s73 offen sc1 lds
  s_waitcnt vmcnt(2)
  s_add_u32 m0, s44, 0
  s_add_u32 s69, s69, 0x4000
  buffer_load_dwordx4 v3, s[20:23], s69 offen lds
  s_add_u32 m0, s44, 0
  s_nop 0
  buffer_load_dwordx4 v11, s[20:23], s69 offen offset:1024 lds
  s_barrier
  ds_read_b128 v[18:21], v1 offset:0
  ds_read_b128 v[22:25], v1 offset:1024
  s_waitcnt lgkmcnt(1)
  v_mfma_f32_32x32x16_bf16 v[60:75], v[124:127], v[18:21], 0
  ds_read_b128 v[252:255], v1 offset:2048
  s_waitcnt lgkmcnt(1)
  v_mfma_f32_32x32x16_bf16 v[60:75], v[128:131], v[22:25], v[60:75]
  ds_read_b128 v[18:21], v1 offset:3072
  s_add_u32 m0, s44, 0x800
  s_add_u32 s69, s69, 0x4000
  buffer_load_dwordx4 v3, s[20:23], s69 offen lds
  s_waitcnt lgkmcnt(1)
  v_mfma_f32_32x32x16_bf16 v[60:75], v[132:135], v[252:255], v[60:75]
  ds_read_b128 v[22:25], v1 offset:4096
  s_waitcnt lgkmcnt(1)
  v_mfma_f32_32x32x16_bf16 v[60:75], v[136:139], v[18:21], v[60:75]
  ds_read_b128 v[252:255], v1 offset:5120
  s_add_u32 m0, s44, 0x800
  s_nop 0
  buffer_load_dwordx4 v11, s[20:23], s69 offen offset:1024 lds
  s_waitcnt lgkmcnt(1)
  v_mfma_f32_32x32x16_bf16 v[60:75], v[140:143], v[22:25], v[60:75]
  ds_read_b128 v[18:21], v1 offset:6144
  s_waitcnt vmcnt(4)
  s_barrier
  s_waitcnt lgkmcnt(1)
  v_mfma_f32_32x32x16_bf16 v[60:75], v[144:147], v[252:255], v[60:75]
  ds_read_b128 v[22:25], v1 offset:7168
  s_add_u32 m0, s43, 0x8000
  s_add_u32 s70, s70, 0x8000
  buffer_load_dwordx4 v1, s[8:11], s70 offen sc1 lds
  s_waitcnt lgkmcnt(1)
  v_mfma_f32_32x32x16_bf16 v[60:75], v[148:151], v[18:21], v[60:75]
  ds_read_b128 v[252:255], v1 offset:8192
  s_waitcnt lgkmcnt(1)
  v_mfma_f32_32x32x16_bf16 v[60:75], v[152:155], v[22:25], v[60:75]
  ds_read_b128 v[18:21], v1 offset:9216
  s_add_u32 m0, s43, 0xa000
  s_add_u32 s71, s71, 0x8000
  buffer_load_dwordx4 v1, s[8:11], s71 offen sc1 lds
  s_waitcnt lgkmcnt(1)
  v_mfma_f32_32x32x16_bf16 v[60:75], v[156:159], v[252:255], v[60:75]
  ds_read_b128 v[22:25], v1 offset:10240
  s_waitcnt lgkmcnt(1)
  v_mfma_f32_32x32x16_bf16 v[60:75], v[160:163], v[18:21], v[60:75]
  ds_read_b128 v[252:255], v1 offset:11264
  s_waitcnt vmcnt(4)
  ds_read_b64_tr_b16 v[28:29], v4 offset:0
  ds_read_b64_tr_b16 v[30:31], v4 offset:1024
  ds_read_b64_tr_b16 v[32:33], v5 offset:0
  ds_read_b64_tr_b16 v[34:35], v5 offset:1024
  s_add_u32 m0, s43, 0xc000
  s_add_u32 s72, s72, 0x8000
  buffer_load_dwordx4 v1, s[8:11], s72 offen sc1 lds
  s_waitcnt lgkmcnt(5)
  v_mfma_f32_32x32x16_bf16 v[60:75], v[164:167], v[22:25], v[60:75]
  ds_read_b128 v[18:21], v1 offset:12288
  s_waitcnt lgkmcnt(5)
  v_mfma_f32_32x32x16_bf16 v[60:75], v[168:171], v[252:255], v[60:75]
  ds_read_b128 v[22:25], v1 offset:13312
  s_add_u32 m0, s43, 0xe000
  s_add_u32 s73, s73, 0x8000
  buffer_load_dwordx4 v1, s[8:11], s73 offen sc1 lds
  s_waitcnt lgkmcnt(1)
  v_mfma_f32_32x32x16_bf16 v[60:75], v[172:175], v[18:21], v[60:75]
  ds_read_b128 v[252:255], v1 offset:14336
  s_waitcnt lgkmcnt(1)
  v_mfma_f32_32x32x16_bf16 v[60:75], v[176:179], v[22:25], v[60:75]
  ds_read_b128 v[18:21], v1 offset:15360
  s_waitcnt vmcnt(4)
  ds_read_b64_tr_b16 v[36:37], v4 offset:2048
  ds_read_b64_tr_b16 v[38:39], v4 offset:3072
  ds_read_b64_tr_b16 v[40:41], v5 offset:2048
  ds_read_b64_tr_b16 v[42:43], v5 offset:3072
  s_add_u32 m0, s44, 0x1000
  s_add_u32 s69, s69, 0x4000
  buffer_load_dwordx4 v3, s[20:23], s69 offen lds
  s_waitcnt lgkmcnt(5)
  v_mfma_f32_32x32x16_bf16 v[60:75], v[180:183], v[252:255], v[60:75]
  ds_read_b128 v[22:25], v1 offset:16384
  s_waitcnt lgkmcnt(5)
  v_mfma_f32_32x32x16_bf16 v[60:75], v[184:187], v[18:21], v[60:75]
  ds_read_b128 v[252:255], v1 offset:17408
  s_add_u32 m0, s44, 0x1000
  s_nop 0
  buffer_load_dwordx4 v11, s[20:23], s69 offen offset:1024 lds
  s_waitcnt lgkmcnt(1)
  v_mfma_f32_32x32x16_bf16 v[60:75], v[188:191], v[22:25], v[60:75]
  ds_read_b128 v[18:21], v1 offset:18432
  s_waitcnt lgkmcnt(1)
  v_mfma_f32_32x32x16_bf16 v[60:75], v[192:195], v[252:255], v[60:75]
  ds_read_b128 v[22:25], v1 offset:19456
  s_add_u32 m0, s44, 0x1800
  s_add_u32 s69, s69, 0x4000
  buffer_load_dwordx4 v3, s[20:23], s69 offen lds
  s_waitcnt lgkmcnt(1)
  v_mfma_f32_32x32x16_bf16 v[60:75], v[196:199], v[18:21], v[60:75]
  ds_read_b128 v[252:255], v1 offset:20480
  s_waitcnt lgkmcnt(1)
  v_mfma_f32_32x32x16_bf16 v[60:75], v[200:203], v[22:25], v[60:75]
  ds_read_b128 v[18:21], v1 offset:21504
  s_add_u32 m0, s44, 0x1800
  s_nop 0
  buffer_load_dwordx4 v11, s[20:23], s69 offen offset:1024 lds
  s_waitcnt lgkmcnt(1)
  v_mfma_f32_32x32x16_bf16 v[60:75], v[204:207], v[252:255], v[60:75]
  ds_read_b128 v[22:25], v1 offset:22528
  s_waitcnt lgkmcnt(1)
  v_mfma_f32_32x32x16_bf16 v[60:75], v[208:211], v[18:21], v[60:75]
  ds_read_b128 v[252:255], v1 offset:23552
  s_add_u32 m0, s44, 0
  s_add_u32 s69, s69, 0x4000
  buffer_load_dwordx4 v3, s[20:23], s69 offen lds
  s_waitcnt lgkmcnt(1)
  v_mfma_f32_32x32x16_bf16 v[60:75], v[212:215], v[22:25], v[60:75]
  ds_read_b128 v[18:21], v1 offset:24576
  s_waitcnt lgkmcnt(1)
  v_mfma_f32_32x32x16_bf16 v[60:75], v[216:219], v[252:255], v[60:75]
  ds_read_b128 v[22:25], v1 offset:25600
  s_add_u32 m0, s44, 0
  s_nop 0
  buffer_load_dwordx4 v11, s[20:23], s69 offen offset:1024 lds
  s_waitcnt lgkmcnt(1)
  v_mfma_f32_32x32x16_bf16 v[60:75], v[220:223], v[18:21], v[60:75]
  ds_read_b128 v[252:255], v1 offset:26624
  s_waitcnt lgkmcnt(1)
  v_mfma_f32_32x32x16_bf16 v[60:75], v[224:227], v[22:25], v[60:75]
  ds_read_b128 v[18:21], v1 offset:27648
  s_waitcnt vmcnt(4)
  ds_read_b64_tr_b16 v[44:45], v4 offset:4096
  ds_read_b64_tr_b16 v[46:47], v4 offset:5120
  ds_read_b64_tr_b16 v[48:49], v5 offset:4096
  ds_read_b64_tr_b16 v[50:51], v5 offset:5120
  s_add_u32 m0, s44, 0x800
  s_add_u32 s69, s69, 0x4000
  buffer_load_dwordx4 v3, s[20:23], s69 offen lds
  s_waitcnt lgkmcnt(5)
  v_mfma_f32_32x32x16_bf16 v[60:75], v[228:231], v[252:255], v[60:75]
  ds_read_b128 v[22:25], v1 offset:28672
  s_waitcnt lgkmcnt(5)
  v_mfma_f32_32x32x16_bf16 v[60:75], v[232:235], v[18:21], v[60:75]
  ds_read_b128 v[252:255], v1 offset:29696
  s_add_u32 m0, s44, 0x800
  s_nop 0
  buffer_load_dwordx4 v11, s[20:23], s69 offen offset:1024 lds
  s_barrier
  ds_read2_b32 v[14:15], v6 offset0:0 offset1:0
  s_waitcnt lgkmcnt(2)
  v_mfma_f32_32x32x16_bf16 v[60:75], v[236:239], v[22:25], v[60:75]
  ds_read_b128 v[18:21], v1 offset:30720
  s_waitcnt lgkmcnt(2)
  v_mfma_f32_32x32x16_bf16 v[60:75], v[240:243], v[252:255], v[60:75]
  ds_read_b128 v[22:25], v1 offset:31744
  s_waitcnt vmcnt(4)
  ds_read_b64_tr_b16 v[52:53], v4 offset:6144
  ds_read_b64_tr_b16 v[54:55], v4 offset:7168
  ds_read_b64_tr_b16 v[56:57], v5 offset:6144
  ds_read_b64_tr_b16 v[58:59], v5 offset:7168
  s_add_u32 m0, s44, 0x1000
  s_add_u32 s69, s69, 0x4000
  buffer_load_dwordx4 v3, s[20:23], s69 offen lds
  s_waitcnt lgkmcnt(5)
  v_mfma_f32_32x32x16_bf16 v[60:75], v[244:247], v[18:21], v[60:75]
  ds_read_b128 v[252:255], v1 offset:32768
  s_waitcnt lgkmcnt(5)
  v_mfma_f32_32x32x16_bf16 v[60:75], v[248:251], v[22:25], v[60:75]
  ds_read_b128 v[18:21], v1 offset:33792
  s_add_u32 m0, s44, 0x1000
  s_nop 0
  buffer_load_dwordx4 v11, s[20:23], s69 offen offset:1024 lds
  v_mfma_f32_32x32x16_bf16 v[60:75], v[12:15], v[14:17], v[60:75]
  s_waitcnt lgkmcnt(1)
  v_mfma_f32_32x32x16_bf16 v[76:91], v[124:127], v[252:255], 0
  ds_read_b128 v[22:25], v1 offset:34816
  s_nop 8
  v_cvt_pk_bf16_f32 v60, v60, v61
  v_cvt_pk_bf16_f32 v61, v62, v63
  v_cvt_pk_bf16_f32 v62, v64, v65
  v_cvt_pk_bf16_f32 v63, v66, v67
  v_pk_max_i16 v60, v60, 0
  v_pk_max_i16 v61, v61, 0
  v_pk_max_i16 v62, v62, 0
  v_pk_max_i16 v63, v63, 0
  buffer_store_dwordx4 v[60:63], v1, s[8:11], s56 offen
  v_cvt_pk_bf16_f32 v68, v68, v69
  s_add_u32 m0, s44, 0x1800
  s_add_u32 s69, s69, 0x4000
  buffer_load_dwordx4 v3, s[20:23], s69 offen lds
  s_waitcnt lgkmcnt(1)
  v_mfma_f32_32x32x16_bf16 v[76:91], v[128:131], v[18:21], v[76:91]
  ds_read_b128 v[252:255], v1 offset:35840
  v_cvt_pk_bf16_f32 v69, v70, v71
  v_cvt_pk_bf16_f32 v70, v72, v73
  v_cvt_pk_bf16_f32 v71, v74, v75
  v_pk_max_i16 v68, v68, 0
  v_pk_max_i16 v69, v69, 0
  v_pk_max_i16 v70, v70, 0
  v_pk_max_i16 v71, v71, 0
  buffer_store_dwordx4 v[68:71], v1, s[8:11], s57 offen
  s_waitcnt lgkmcnt(1)
  v_mfma_f32_32x32x16_bf16 v[76:91], v[132:135], v[22:25], v[76:91]
  ds_read_b128 v[18:21], v1 offset:36864
  s_waitcnt vmcnt(7)
  ds_read_b64_tr_b16 v[124:125], v4 offset:0
  ds_read_b64_tr_b16 v[126:127], v4 offset:1024
  ds_read_b64_tr_b16 v[128:129], v5 offset:0
  ds_read_b64_tr_b16 v[130:131], v5 offset:1024
  s_add_u32 m0, s44, 0x1800
  s_nop 0
  buffer_load_dwordx4 v11, s[20:23], s69 offen offset:1024 lds
  s_waitcnt lgkmcnt(5)
  v_mfma_f32_32x32x16_bf16 v[76:91], v[136:139], v[252:255], v[76:91]
  ds_read_b128 v[22:25], v1 offset:37888
  s_waitcnt lgkmcnt(5)
  v_mfma_f32_32x32x16_bf16 v[76:91], v[140:143], v[18:21], v[76:91]
  ds_read_b128 v[252:255], v1 offset:38912
  s_waitcnt vmcnt(6)
  ds_read_b64_tr_b16 v[132:133], v4 offset:2048
  ds_read_b64_tr_b16 v[134:135], v4 offset:3072
  ds_read_b64_tr_b16 v[136:137], v5 offset:2048
  ds_read_b64_tr_b16 v[138:139], v5 offset:3072
  s_add_u32 m0, s44, 0
  s_add_u32 s69, s69, 0x4000
  buffer_load_dwordx4 v3, s[20:23], s69 offen lds
  s_waitcnt lgkmcnt(5)
  v_mfma_f32_32x32x16_bf16 v[76:91], v[144:147], v[22:25], v[76:91]
  ds_read_b128 v[18:21], v1 offset:39936
  s_waitcnt lgkmcnt(5)
  v_mfma_f32_32x32x16_bf16 v[76:91], v[148:151], v[252:255], v[76:91]
  ds_read_b128 v[22:25], v1 offset:40960
  s_add_u32 m0, s44, 0
  s_nop 0
  buffer_load_dwordx4 v11, s[20:23], s69 offen offset:1024 lds
  s_waitcnt lgkmcnt(1)
  v_mfma_f32_32x32x16_bf16 v[76:91], v[152:155], v[18:21], v[76:91]
  ds_read_b128 v[252:255], v1 offset:41984
  s_waitcnt lgkmcnt(1)
  v_mfma_f32_32x32x16_bf16 v[76:91], v[156:159], v[22:25], v[76:91]
  ds_read_b128 v[18:21], v1 offset:43008
  s_waitcnt vmcnt(6)
  ds_read_b64_tr_b16 v[140:141], v4 offset:4096
  ds_read_b64_tr_b16 v[142:143], v4 offset:5120
  ds_read_b64_tr_b16 v[144:145], v5 offset:4096
  ds_read_b64_tr_b16 v[146:147], v5 offset:5120
  s_add_u32 m0, s44, 0x800
  s_add_u32 s69, s69, 0x4000
  buffer_load_dwordx4 v3, s[20:23], s69 offen lds
  s_waitcnt lgkmcnt(5)
  v_mfma_f32_32x32x16_bf16 v[76:91], v[160:163], v[252:255], v[76:91]
  ds_read_b128 v[22:25], v1 offset:44032
  s_waitcnt vmcnt(4)
  s_add_u32 s36, s60, 0x4000
  s_cmp_lg_u32 s52, 0
  s_mov_b64 exec, 1
  s_cbranch_scc1 k6_kernel_pub23
  buffer_store_dword v2, off, s[8:11], s36
k6_kernel_pb24:
  s_mov_b64 exec, -1
  s_waitcnt lgkmcnt(5)
  v_mfma_f32_32x32x16_bf16 v[76:91], v[164:167], v[18:21], v[76:91]
  ds_read_b128 v[252:255], v1 offset:45056
  s_add_u32 m0, s44, 0x800
  s_nop 0
  buffer_load_dwordx4 v11, s[20:23], s69 offen offset:1024 lds
  s_waitcnt lgkmcnt(1)
  v_mfma_f32_32x32x16_bf16 v[76:91], v[168:171], v[22:25], v[76:91]
  ds_read_b128 v[18:21], v1 offset:46080
  s_waitcnt lgkmcnt(1)
  v_mfma_f32_32x32x16_bf16 v[76:91], v[172:175], v[252:255], v[76:91]
  ds_read_b128 v[22:25], v1 offset:47104
  s_waitcnt vmcnt(5)
  ds_read_b64_tr_b16 v[148:149], v4 offset:6144
  ds_read_b64_tr_b16 v[150:151], v4 offset:7168
  ds_read_b64_tr_b16 v[152:153], v5 offset:6144
  ds_read_b64_tr_b16 v[154:155], v5 offset:7168
  s_waitcnt lgkmcnt(5)
  v_mfma_f32_32x32x16_bf16 v[76:91], v[176:179], v[18:21], v[76:91]
  ds_read_b128 v[252:255], v1 offset:48128
  s_waitcnt lgkmcnt(5)
  v_mfma_f32_32x32x16_bf16 v[76:91], v[180:183], v[22:25], v[76:91]
  ds_read_b128 v[18:21], v1 offset:49152
  s_waitcnt lgkmcnt(1)
  v_mfma_f32_32x32x16_bf16 v[76:91], v[184:187], v[252:255], v[76:91]
  ds_read_b128 v[22:25], v1 offset:50176
  buffer_load_dword v26, v0, s[8:11], s62 offen sc1
  s_waitcnt lgkmcnt(1)
  v_mfma_f32_32x32x16_bf16 v[76:91], v[188:191], v[18:21], v[76:91]
  ds_read_b128 v[252:255], v1 offset:51200
  s_waitcnt vmcnt(4)
  ds_read_b64_tr_b16 v[156:157], v4 offset:0
  ds_read_b64_tr_b16 v[158:159], v4 offset:1024
  ds_read_b64_tr_b16 v[160:161], v5 offset:0
  ds_read_b64_tr_b16 v[162:163], v5 offset:1024
  s_waitcnt lgkmcnt(5)
  v_mfma_f32_32x32x16_bf16 v[76:91], v[192:195], v[22:25], v[76:91]
  ds_read_b128 v[18:21], v1 offset:52224
  s_waitcnt lgkmcnt(5)
  v_mfma_f32_32x32x16_bf16 v[76:91], v[196:199], v[252:255], v[76:91]
  ds_read_b128 v[22:25], v1 offset:53248
  s_waitcnt lgkmcnt(1)
  v_mfma_f32_32x32x16_bf16 v[76:91], v[200:203], v[18:21], v[76:91]
  ds_read_b128 v[252:255], v1 offset:54272
  s_waitcnt lgkmcnt(1)
  v_mfma_f32_32x32x16_bf16 v[76:91], v[204:207], v[22:25], v[76:91]
  ds_read_b128 v[18:21], v1 offset:55296
  s_waitcnt vmcnt(1)
  ds_read_b64_tr_b16 v[164:165], v4 offset:2048
  ds_read_b64_tr_b16 v[166:167], v4 offset:3072
  ds_read_b64_tr_b16 v[168:169], v5 offset:2048
  ds_read_b64_tr_b16 v[170:171], v5 offset:3072
  s_waitcnt vmcnt(0)
  v_cmp_eq_u32 vcc, s51, v26
  s_cmp_eq_u64 vcc, -1
  s_cbranch_scc0 k6_kernel_pq25
k6_kernel_pr26:
  buffer_load_dwordx4 v[172:175], v1, s[8:11], s74 offen offset:0 sc1
  buffer_load_dwordx4 v[176:179], v1, s[8:11], s74 offen offset:1024 sc1
  buffer_load_dwordx4 v[180:183], v1, s[8:11], s74 offen offset:2048 sc1
  buffer_load_dwordx4 v[184:187], v1, s[8:11], s74 offen offset:3072 sc1
  s_add_u32 s74, s74, 0x1000
  buffer_load_dwordx4 v[188:191], v1, s[8:11], s74 offen offset:0 sc1
  buffer_load_dwordx4 v[192:195], v1, s[8:11], s74 offen offset:1024 sc1
  s_waitcnt lgkmcnt(5)
  v_mfma_f32_32x32x16_bf16 v[76:91], v[208:211], v[252:255], v[76:91]
  ds_read_b128 v[22:25], v1 offset:56320
  buffer_load_dwordx4 v[196:199], v1, s[8:11], s74 offen offset:2048 sc1
  s_waitcnt lgkmcnt(5)
  v_mfma_f32_32x32x16_bf16 v[76:91], v[212:215], v[18:21], v[76:91]
  ds_read_b128 v[252:255], v1 offset:57344
  buffer_load_dwordx4 v[200:203], v1, s[8:11], s74 offen offset:3072 sc1
  s_waitcnt lgkmcnt(1)
  v_mfma_f32_32x32x16_bf16 v[76:91], v[216:219], v[22:25], v[76:91]
  ds_read_b128 v[18:21], v1 offset:58368
  s_add_u32 s74, s74, 0x1000
  buffer_load_dwordx4 v[204:207], v1, s[8:11], s74 offen offset:0 sc1
  s_waitcnt lgkmcnt(1)
  v_mfma_f32_32x32x16_bf16 v[76:91], v[220:223], v[252:255], v[76:91]
  ds_read_b128 v[22:25], v1 offset:59392
  buffer_load_dwordx4 v[208:211], v1, s[8:11], s74 offen offset:1024 sc1
  s_waitcnt lgkmcnt(1)
  v_mfma_f32_32x32x16_bf16 v[76:91], v[224:227], v[18:21], v[76:91]
  ds_read_b128 v[252:255], v1 offset:60416
  buffer_load_dwordx4 v[212:215], v1, s[8:11], s74 offen offset:2048 sc1
  s_waitcnt lgkmcnt(1)
  v_mfma_f32_32x32x16_bf16 v[76:91], v[228:231], v[22:25], v[76:91]
  ds_read_b128 v[18:21], v1 offset:61440
  buffer_load_dwordx4 v[216:219], v1, s[8:11], s74 offen offset:3072 sc1
  s_waitcnt lgkmcnt(1)
  v_mfma_f32_32x32x16_bf16 v[76:91], v[232:235], v[252:255], v[76:91]
  ds_read_b128 v[22:25], v1 offset:62464
  s_add_u32 s74, s74, 0x1000
  buffer_load_dwordx4 v[220:223], v1, s[8:11], s74 offen offset:0 sc1
  s_barrier
  ds_read2_b32 v[14:15], v6 offset0:32 offset1:32
  s_waitcnt lgkmcnt(2)
  v_mfma_f32_32x32x16_bf16 v[76:91], v[236:239], v[18:21], v[76:91]
  ds_read_b128 v[252:255], v1 offset:63488
  buffer_load_dwordx4 v[224:227], v1, s[8:11], s74 offen offset:1024 sc1
  s_waitcnt lgkmcnt(2)
  v_mfma_f32_32x32x16_bf16 v[76:91], v[240:243], v[22:25], v[76:91]
  ds_read_b128 v[18:21], v1 offset:64512
  s_waitcnt lgkmcnt(1)
  v_mfma_f32_32x32x16_bf16 v[76:91], v[244:247], v[252:255], v[76:91]
  s_waitcnt lgkmcnt(0)
  v_mfma_f32_32x32x16_bf16 v[76:91], v[248:251], v[18:21], v[76:91]
  v_mfma_f32_32x32x16_bf16 v[76:91], v[12:15], v[14:17], v[76:91]
  s_waitcnt vmcnt(13)
  v_mfma_f32_32x32x16_bf16 v[60:75], v[92:95], v[172:175], 0
  s_nop 9
  v_cvt_pk_bf16_f32 v76, v76, v77
  v_cvt_pk_bf16_f32 v77, v78, v79
  v_cvt_pk_bf16_f32 v78, v80, v81
  v_cvt_pk_bf16_f32 v79, v82, v83
  v_pk_max_i16 v76, v76, 0
  v_pk_max_i16 v77, v77, 0
  v_pk_max_i16 v78, v78, 0
  v_pk_max_i16 v79, v79, 0
  s_add_u32 s56, s56, 0x1c000
  buffer_store_dwordx4 v[76:79], v1, s[8:11], s56 offen
  v_mfma_f32_32x32x16_bf16 v[12:27], v[96:99], v[172:175], 0
  v_cvt_pk_bf16_f32 v84, v84, v85
  v_cvt_pk_bf16_f32 v85, v86, v87
  v_cvt_pk_bf16_f32 v86, v88, v89
  v_cvt_pk_bf16_f32 v87, v90, v91
  v_pk_max_i16 v84, v84, 0
  v_pk_max_i16 v85, v85, 0
  v_pk_max_i16 v86, v86, 0
  v_pk_max_i16 v87, v87, 0
  s_add_u32 s57, s57, 0x1c000
  buffer_store_dwordx4 v[84:87], v1, s[8:11], s57 offen
  s_waitcnt vmcnt(14)
  v_mfma_f32_32x32x16_bf16 v[60:75], v[100:103], v[176:179], v[60:75]
  v_mfma_f32_32x32x16_bf16 v[12:27], v[104:107], v[176:179], v[12:27]
  s_waitcnt vmcnt(13)
  v_mfma_f32_32x32x16_bf16 v[60:75], v[108:111], v[180:183], v[60:75]
  v_mfma_f32_32x32x16_bf16 v[12:27], v[112:115], v[180:183], v[12:27]
  v_lshrrev_b32 v11, 10, v9
  v_bfe_u32 v3, v9, 3, 1
  v_lshl_add_u32 v3, v3, 5, v11
  v_lshlrev_b32 v3, 4, v3
  v_and_b32 v244, 16, v9
  v_lshrrev_b32 v244, 1, v244
  v_add_u32 v3, v3, v244
  v_and_b32 v244, 0x60, v9
  v_lshl_add_u32 v3, v244, 5, v3
  s_lshl_b32 s7, s66, 1
  s_sub_u32 s7, s67, s7
  s_and_b32 s7, s7, 7
  s_lshl_b32 s7, s7, 12
  v_add_u32 v3, s7, v3
  v_lshlrev_b32 v11, 2, v11
  v_add_u32 v11, 0x24e00, v11
  ds_read_b64 v[244:245], v3
  ds_read_b64 v[246:247], v3 offset:32768
  ds_read2_b32 v[248:249], v11 offset0:0 offset1:32
  s_waitcnt vmcnt(12)
  v_mfma_f32_32x32x16_bf16 v[60:75], v[116:119], v[184:187], v[60:75]
  v_mfma_f32_32x32x16_bf16 v[12:27], v[120:123], v[184:187], v[12:27]
  s_waitcnt vmcnt(11)
  v_mfma_f32_32x32x16_bf16 v[60:75], v[28:31], v[188:191], v[60:75]
  v_mfma_f32_32x32x16_bf16 v[12:27], v[32:35], v[188:191], v[12:27]
  s_waitcnt vmcnt(0)
  s_add_u32 s36, s60, 0x8000
  s_cmp_lg_u32 s52, 0
  s_mov_b64 exec, 1
  s_cbranch_scc1 k6_kernel_pub27
  buffer_store_dword v2, off, s[8:11], s36
k6_kernel_pb28:
  s_mov_b64 exec, -1
  v_mfma_f32_32x32x16_bf16 v[60:75], v[36:39], v[192:195], v[60:75]
  v_mfma_f32_32x32x16_bf16 v[12:27], v[40:43], v[192:195], v[12:27]
  v_mfma_f32_32x32x16_bf16 v[60:75], v[44:47], v[196:199], v[60:75]
  v_mfma_f32_32x32x16_bf16 v[12:27], v[48:51], v[196:199], v[12:27]
  v_mfma_f32_32x32x16_bf16 v[60:75], v[52:55], v[200:203], v[60:75]
  v_mfma_f32_32x32x16_bf16 v[12:27], v[56:59], v[200:203], v[12:27]
  s_add_u32 s62, s62, 0x4000
  buffer_load_dword v252, v0, s[8:11], s62 offen sc1
  v_mfma_f32_32x32x16_bf16 v[60:75], v[124:127], v[204:207], v[60:75]
  v_mfma_f32_32x32x16_bf16 v[12:27], v[128:131], v[204:207], v[12:27]
  s_waitcnt lgkmcnt(0)
  s_barrier
  v_mfma_f32_32x32x16_bf16 v[60:75], v[132:135], v[208:211], v[60:75]
  v_mfma_f32_32x32x16_bf16 v[12:27], v[136:139], v[208:211], v[12:27]
  v_mfma_f32_32x32x16_bf16 v[60:75], v[140:143], v[212:215], v[60:75]
  v_mfma_f32_32x32x16_bf16 v[12:27], v[144:147], v[212:215], v[12:27]
  s_waitcnt vmcnt(0)
  v_cmp_eq_u32 vcc, s51, v252
  s_cmp_eq_u64 vcc, -1
  s_cbranch_scc0 k6_kernel_pq29
k6_kernel_pr30:
  s_add_u32 s74, s74, 0x19000
  buffer_load_dwordx4 v[172:175], v1, s[8:11], s74 offen offset:0 sc1
  buffer_load_dwordx4 v[176:179], v1, s[8:11], s74 offen offset:1024 sc1
  buffer_load_dwordx4 v[180:183], v1, s[8:11], s74 offen offset:2048 sc1
  buffer_load_dwordx4 v[184:187], v1, s[8:11], s74 offen offset:3072 sc1
  v_mfma_f32_32x32x16_bf16 v[60:75], v[148:151], v[216:219], v[60:75]
  v_mfma_f32_32x32x16_bf16 v[12:27], v[152:155], v[216:219], v[12:27]
  s_add_u32 s74, s74, 0x1000
  buffer_load_dwordx4 v[188:191], v1, s[8:11], s74 offen offset:0 sc1
  v_mfma_f32_32x32x16_bf16 v[60:75], v[156:159], v[220:223], v[60:75]
  v_mfma_f32_32x32x16_bf16 v[12:27], v[160:163], v[220:223], v[12:27]
  buffer_load_dwordx4 v[192:195], v1, s[8:11], s74 offen offset:1024 sc1
  v_mfma_f32_32x32x16_bf16 v[60:75], v[164:167], v[224:227], v[60:75]
  v_mfma_f32_32x32x16_bf16 v[12:27], v[168:171], v[224:227], v[12:27]
  buffer_load_dwordx4 v[196:199], v1, s[8:11], s74 offen offset:2048 sc1
  s_waitcnt vmcnt(6)
  v_mfma_f32_32x32x16_bf16 v[228:243], v[92:95], v[172:175], 0
  v_mfma_f32_32x32x16_bf16 v[76:91], v[96:99], v[172:175], 0
  buffer_load_dwordx4 v[200:203], v1, s[8:11], s74 offen offset:3072 sc1
  s_nop 5
  ds_write_b128 v7, v[60:63] offset:0
  ds_write_b128 v7, v[64:67] offset:1056
  ds_write_b128 v7, v[68:71] offset:2112
  ds_write_b128 v7, v[72:75] offset:3168
  s_waitcnt vmcnt(6)
  v_mfma_f32_32x32x16_bf16 v[228:243], v[100:103], v[176:179], v[228:243]
  v_mfma_f32_32x32x16_bf16 v[76:91], v[104:107], v[176:179], v[76:91]
  s_add_u32 s74, s74, 0x1000
  buffer_load_dwordx4 v[204:207], v1, s[8:11], s74 offen offset:0 sc1
  ds_write_b128 v7, v[12:15] offset:4224
  ds_write_b128 v7, v[16:19] offset:5280
  ds_write_b128 v7, v[20:23] offset:6336
  ds_write_b128 v7, v[24:27] offset:7392
  s_waitcnt vmcnt(6)
  v_mfma_f32_32x32x16_bf16 v[228:243], v[108:111], v[180:183], v[228:243]
  v_mfma_f32_32x32x16_bf16 v[76:91], v[112:115], v[180:183], v[76:91]
  buffer_load_dwordx4 v[208:211], v1, s[8:11], s74 offen offset:1024 sc1
  s_waitcnt vmcnt(6)
  v_mfma_f32_32x32x16_bf16 v[228:243], v[116:119], v[184:187], v[228:243]
  v_mfma_f32_32x32x16_bf16 v[76:91], v[120:123], v[184:187], v[76:91]
  buffer_load_dwordx4 v[212:215], v1, s[8:11], s74 offen offset:2048 sc1
  s_waitcnt vmcnt(6)
  v_mfma_f32_32x32x16_bf16 v[228:243], v[28:31], v[188:191], v[228:243]
  v_mfma_f32_32x32x16_bf16 v[76:91], v[32:35], v[188:191], v[76:91]
  buffer_load_dwordx4 v[216:219], v1, s[8:11], s74 offen offset:3072 sc1
  s_waitcnt lgkmcnt(0)
  s_barrier
  v_add_u32 v7, 0x14500, v7
  ds_read_b128 v[60:63], v8 offset:0
  ds_read_b128 v[64:67], v8 offset:8448
  ds_read_b128 v[68:71], v8 offset:16896
  ds_read_b128 v[72:75], v8 offset:25344
  ds_read_b128 v[12:15], v8 offset:33792
  ds_read_b128 v[16:19], v8 offset:42240
  ds_read_b128 v[20:23], v8 offset:50688
  ds_read_b128 v[24:27], v8 offset:59136
  s_waitcnt vmcnt(6)
  v_mfma_f32_32x32x16_bf16 v[228:243], v[36:39], v[192:195], v[228:243]
  v_mfma_f32_32x32x16_bf16 v[76:91], v[40:43], v[192:195], v[76:91]
  s_add_u32 s74, s74, 0x1000
  buffer_load_dwordx4 v[220:223], v1, s[8:11], s74 offen offset:0 sc1
  s_waitcnt vmcnt(6)
  v_mfma_f32_32x32x16_bf16 v[228:243], v[44:47], v[196:199], v[228:243]
  v_mfma_f32_32x32x16_bf16 v[76:91], v[48:51], v[196:199], v[76:91]
  buffer_load_dwordx4 v[224:227], v1, s[8:11], s74 offen offset:1024 sc1
  s_waitcnt vmcnt(6)
  v_mfma_f32_32x32x16_bf16 v[228:243], v[52:55], v[200:203], v[228:243]
  v_mfma_f32_32x32x16_bf16 v[76:91], v[56:59], v[200:203], v[76:91]
  s_waitcnt lgkmcnt(6)
  v_pk_add_f32 v[60:61], v[60:61], v[64:65]
  v_pk_add_f32 v[62:63], v[62:63], v[66:67]
  s_waitcnt lgkmcnt(4)
  v_pk_add_f32 v[68:69], v[68:69], v[72:73]
  v_pk_add_f32 v[70:71], v[70:71], v[74:75]
  s_waitcnt lgkmcnt(2)
  v_pk_add_f32 v[12:13], v[12:13], v[16:17]
  v_pk_add_f32 v[14:15], v[14:15], v[18:19]
  s_waitcnt lgkmcnt(0)
  v_pk_add_f32 v[20:21], v[20:21], v[24:25]
  v_pk_add_f32 v[22:23], v[22:23], v[26:27]
  v_pk_add_f32 v[60:61], v[60:61], v[68:69]
  v_pk_add_f32 v[62:63], v[62:63], v[70:71]
  v_pk_add_f32 v[12:13], v[12:13], v[20:21]
  v_pk_add_f32 v[14:15], v[14:15], v[22:23]
  v_pk_add_f32 v[60:61], v[60:61], v[12:13]
  v_pk_add_f32 v[62:63], v[62:63], v[14:15]
  v_lshlrev_b32 v64, 16, v244
  v_and_b32 v65, 0xffff0000, v244
  v_lshlrev_b32 v66, 16, v245
  v_and_b32 v67, 0xffff0000, v245
  v_fma_f32 v64, v60, v248, v64
  v_fma_f32 v65, v61, v248, v65
  v_fma_f32 v66, v62, v248, v66
  v_fma_f32 v67, v63, v248, v67
  v_cvt_pk_bf16_f32 v64, v64, v65
  v_cvt_pk_bf16_f32 v65, v66, v67
  buffer_store_dwordx2 v[64:65], v9, s[28:31], s75 offen
  s_waitcnt vmcnt(6)
  v_mfma_f32_32x32x16_bf16 v[228:243], v[124:127], v[204:207], v[228:243]
  v_mfma_f32_32x32x16_bf16 v[76:91], v[128:131], v[204:207], v[76:91]
  s_waitcnt vmcnt(5)
  v_mfma_f32_32x32x16_bf16 v[228:243], v[132:135], v[208:211], v[228:243]
  v_mfma_f32_32x32x16_bf16 v[76:91], v[136:139], v[208:211], v[76:91]
  s_waitcnt vmcnt(4)
  v_mfma_f32_32x32x16_bf16 v[228:243], v[140:143], v[212:215], v[228:243]
  s_waitcnt vmcnt(3)
  v_mfma_f32_32x32x16_bf16 v[228:243], v[148:151], v[216:219], v[228:243]
  s_waitcnt vmcnt(2)
  v_mfma_f32_32x32x16_bf16 v[228:243], v[156:159], v[220:223], v[228:243]
  s_waitcnt vmcnt(1)
  v_mfma_f32_32x32x16_bf16 v[228:243], v[164:167], v[224:227], v[228:243]
  v_mfma_f32_32x32x16_bf16 v[76:91], v[144:147], v[212:215], v[76:91]
  v_mfma_f32_32x32x16_bf16 v[76:91], v[152:155], v[216:219], v[76:91]
  s_nop 9
  ds_write_b128 v7, v[228:231] offset:0
  ds_write_b128 v7, v[232:235] offset:1056
  ds_write_b128 v7, v[236:239] offset:2112
  ds_write_b128 v7, v[240:243] offset:3168
  v_mfma_f32_32x32x16_bf16 v[76:91], v[160:163], v[220:223], v[76:91]
  v_mfma_f32_32x32x16_bf16 v[76:91], v[168:171], v[224:227], v[76:91]
  s_nop 11
  ds_write_b128 v7, v[76:79] offset:4224
  ds_write_b128 v7, v[80:83] offset:5280
  ds_write_b128 v7, v[84:87] offset:6336
  ds_write_b128 v7, v[88:91] offset:7392
  v_add_u32 v8, 0x14500, v8
  s_waitcnt lgkmcnt(0)
  s_barrier
  ds_read_b128 v[228:231], v8 offset:0
  ds_read_b128 v[232:235], v8 offset:8448
  ds_read_b128 v[236:239], v8 offset:16896
  ds_read_b128 v[240:243], v8 offset:25344
  ds_read_b128 v[76:79], v8 offset:33792
  ds_read_b128 v[80:83], v8 offset:42240
  ds_read_b128 v[84:87], v8 offset:50688
  ds_read_b128 v[88:91], v8 offset:59136
  s_waitcnt lgkmcnt(6)
  v_pk_add_f32 v[228:229], v[228:229], v[232:233]
  v_pk_add_f32 v[230:231], v[230:231], v[234:235]
  s_waitcnt lgkmcnt(4)
  v_pk_add_f32 v[236:237], v[236:237], v[240:241]
  v_pk_add_f32 v[238:239], v[238:239], v[242:243]
  s_waitcnt lgkmcnt(2)
  v_pk_add_f32 v[76:77], v[76:77], v[80:81]
  v_pk_add_f32 v[78:79], v[78:79], v[82:83]
  s_waitcnt lgkmcnt(0)
  v_pk_add_f32 v[84:85], v[84:85], v[88:89]
  v_pk_add_f32 v[86:87], v[86:87], v[90:91]
  v_pk_add_f32 v[228:229], v[228:229], v[236:237]
  v_pk_add_f32 v[230:231], v[230:231], v[238:239]
  v_pk_add_f32 v[76:77], v[76:77], v[84:85]
  v_pk_add_f32 v[78:79], v[78:79], v[86:87]
  v_pk_add_f32 v[228:229], v[228:229], v[76:77]
  v_pk_add_f32 v[230:231], v[230:231], v[78:79]
  v_lshlrev_b32 v232, 16, v246
  v_and_b32 v233, 0xffff0000, v246
  v_lshlrev_b32 v234, 16, v247
  v_and_b32 v235, 0xffff0000, v247
  v_fma_f32 v232, v228, v249, v232
  v_fma_f32 v233, v229, v249, v233
  v_fma_f32 v234, v230, v249, v234
  v_fma_f32 v235, v231, v249, v235
  v_cvt_pk_bf16_f32 v232, v232, v233
  v_cvt_pk_bf16_f32 v233, v234, v235
  s_add_u32 s75, s75, 0x8000
  buffer_store_dwordx2 v[232:233], v9, s[28:31], s75 offen
  s_endpgm
k6_kernel_w718:
  v_lshrrev_b32 v76, 4, v1
  v_add_u32 v6, 0x24d00, v9
  v_lshrrev_b32 v77, 5, v76
  v_mul_u32_u24 v77, 0x210, v77
  v_and_b32 v78, 0x1f0, v1
  v_add_u32 v77, v77, v78
  s_sub_u32 s7, s44, 0x14500
  v_add_u32 v7, s7, v77
  v_and_b32 v77, 15, v76
  v_lshrrev_b32 v78, 4, v76
  s_lshl_b32 s7, s6, 2
  v_add_u32 v78, s7, v78
  v_mul_u32_u24 v8, 0x210, v77
  v_lshl_add_u32 v8, v78, 4, v8
  v_lshlrev_b32 v9, 3, v77
  v_lshl_add_u32 v9, v78, 10, v9
  s_waitcnt vmcnt(0)
  s_cmp_lg_u32 s52, 0
  s_mov_b64 exec, 1
  s_cbranch_scc1 k6_kernel_pub31
  buffer_store_dword v2, off, s[8:11], s60
k6_kernel_pb32:
  s_mov_b64 exec, -1
  buffer_load_dword v79, v10, s[8:11], s61 offen sc1
  s_waitcnt vmcnt(0)
  v_cmp_eq_u32 vcc, s51, v79
  s_cmp_eq_u64 vcc, -1
  s_cbranch_scc0 k6_kernel_pq33
k6_kernel_pr34:
  s_add_u32 m0, s43, 0
  s_nop 0
  buffer_load_dwordx4 v1, s[8:11], s70 offen sc1 lds
  s_add_u32 m0, s43, 0x2000
  s_nop 0
  buffer_load_dwordx4 v1, s[8:11], s71 offen sc1 lds
  s_add_u32 m0, s43, 0x4000
  s_nop 0
  buffer_load_dwordx4 v1, s[8:11], s72 offen sc1 lds
  s_add_u32 m0, s43, 0x6000
  s_nop 0
  buffer_load_dwordx4 v1, s[8:11], s73 offen sc1 lds
  s_waitcnt vmcnt(2)
  s_add_u32 m0, s43, 0x8000
  s_add_u32 s70, s70, 0x8000
  buffer_load_dwordx4 v1, s[8:11], s70 offen sc1 lds
  s_add_u32 m0, s43, 0xa000
  s_add_u32 s71, s71, 0x8000
  buffer_load_dwordx4 v1, s[8:11], s71 offen sc1 lds
  s_barrier
  s_setprio 3
  v_lshrrev_b32 v60, 4, v1
  v_bfe_u32 v61, v60, 2, 1
  v_bfe_u32 v62, v60, 4, 1
  v_cmp_eq_u32 vcc, v61, v62
  v_mov_b32 v61, 0x3f803f80
  s_nop 0
  v_cndmask_b32 v12, 0, v61, vcc
  v_mov_b32 v13, v12
  v_mov_b32 v14, v12
  v_mov_b32 v15, v12
  v_mov_b32 v20, 0
  v_mov_b32 v21, 0
  v_mov_b32 v22, 0
  v_mov_b32 v23, 0
  ds_read_b128 v[76:79], v1 offset:0
  ds_read_b128 v[80:83], v1 offset:1024
  ds_read_b128 v[84:87], v1 offset:2048
  ds_read_b128 v[88:91], v1 offset:3072
  s_waitcnt lgkmcnt(3)
  v_mfma_f32_16x16x32_bf16 v[16:19], v[12:15], v[76:79], 0
  v_dot2_f32_bf16 v20, v76, v76, v20
  v_dot2_f32_bf16 v21, v77, v77, v21
  v_dot2_f32_bf16 v22, v78, v78, v22
  v_dot2_f32_bf16 v23, v79, v79, v23
  ds_read_b128 v[76:79], v1 offset:4096
  s_waitcnt lgkmcnt(3)
  v_mfma_f32_16x16x32_bf16 v[16:19], v[12:15], v[80:83], v[16:19]
  v_dot2_f32_bf16 v20, v80, v80, v20
  v_dot2_f32_bf16 v21, v81, v81, v21
  v_dot2_f32_bf16 v22, v82, v82, v22
  v_dot2_f32_bf16 v23, v83, v83, v23
  s_add_u32 m0, s43, 0xc000
  s_add_u32 s72, s72, 0x8000
  buffer_load_dwordx4 v1, s[8:11], s72 offen sc1 lds
  ds_read_b128 v[80:83], v1 offset:5120
  s_waitcnt lgkmcnt(3)
  v_mfma_f32_16x16x32_bf16 v[16:19], v[12:15], v[84:87], v[16:19]
  v_dot2_f32_bf16 v20, v84, v84, v20
  v_dot2_f32_bf16 v21, v85, v85, v21
  v_dot2_f32_bf16 v22, v86, v86, v22
  v_dot2_f32_bf16 v23, v87, v87, v23
  ds_read_b128 v[84:87], v1 offset:6144
  s_waitcnt lgkmcnt(3)
  v_mfma_f32_16x16x32_bf16 v[16:19], v[12:15], v[88:91], v[16:19]
  v_dot2_f32_bf16 v20, v88, v88, v20
  v_dot2_f32_bf16 v21, v89, v89, v21
  v_dot2_f32_bf16 v22, v90, v90, v22
  v_dot2_f32_bf16 v23, v91, v91, v23
  s_add_u32 m0, s43, 0xe000
  s_add_u32 s73, s73, 0x8000
  buffer_load_dwordx4 v1, s[8:11], s73 offen sc1 lds
  s_waitcnt vmcnt(4)
  s_barrier
  ds_read_b128 v[88:91], v1 offset:7168
  s_waitcnt lgkmcnt(3)
  v_mfma_f32_16x16x32_bf16 v[16:19], v[12:15], v[76:79], v[16:19]
  v_dot2_f32_bf16 v20, v76, v76, v20
  v_dot2_f32_bf16 v21, v77, v77, v21
  v_dot2_f32_bf16 v22, v78, v78, v22
  v_dot2_f32_bf16 v23, v79, v79, v23
  ds_read_b128 v[76:79], v1 offset:8192
  s_waitcnt lgkmcnt(3)
  v_mfma_f32_16x16x32_bf16 v[16:19], v[12:15], v[80:83], v[16:19]
  v_dot2_f32_bf16 v20, v80, v80, v20
  v_dot2_f32_bf16 v21, v81, v81, v21
  v_dot2_f32_bf16 v22, v82, v82, v22
  v_dot2_f32_bf16 v23, v83, v83, v23
  ds_read_b128 v[80:83], v1 offset:9216
  s_waitcnt lgkmcnt(3)
  v_mfma_f32_16x16x32_bf16 v[16:19], v[12:15], v[84:87], v[16:19]
  v_dot2_f32_bf16 v20, v84, v84, v20
  v_dot2_f32_bf16 v21, v85, v85, v21
  v_dot2_f32_bf16 v22, v86, v86, v22
  v_dot2_f32_bf16 v23, v87, v87, v23
  ds_read_b128 v[84:87], v1 offset:10240
  s_waitcnt lgkmcnt(3)
  v_mfma_f32_16x16x32_bf16 v[16:19], v[12:15], v[88:91], v[16:19]
  v_dot2_f32_bf16 v20, v88, v88, v20
  v_dot2_f32_bf16 v21, v89, v89, v21
  v_dot2_f32_bf16 v22, v90, v90, v22
  v_dot2_f32_bf16 v23, v91, v91, v23
  ds_read_b128 v[88:91], v1 offset:11264
  s_waitcnt lgkmcnt(3)
  v_mfma_f32_16x16x32_bf16 v[16:19], v[12:15], v[76:79], v[16:19]
  v_dot2_f32_bf16 v20, v76, v76, v20
  v_dot2_f32_bf16 v21, v77, v77, v21
  v_dot2_f32_bf16 v22, v78, v78, v22
  v_dot2_f32_bf16 v23, v79, v79, v23
  ds_read_b128 v[76:79], v1 offset:12288
  s_waitcnt lgkmcnt(3)
  v_mfma_f32_16x16x32_bf16 v[16:19], v[12:15], v[80:83], v[16:19]
  v_dot2_f32_bf16 v20, v80, v80, v20
  v_dot2_f32_bf16 v21, v81, v81, v21
  v_dot2_f32_bf16 v22, v82, v82, v22
  v_dot2_f32_bf16 v23, v83, v83, v23
  ds_read_b128 v[80:83], v1 offset:13312
  s_waitcnt lgkmcnt(3)
  v_mfma_f32_16x16x32_bf16 v[16:19], v[12:15], v[84:87], v[16:19]
  v_dot2_f32_bf16 v20, v84, v84, v20
  v_dot2_f32_bf16 v21, v85, v85, v21
  v_dot2_f32_bf16 v22, v86, v86, v22
  v_dot2_f32_bf16 v23, v87, v87, v23
  ds_read_b128 v[84:87], v1 offset:14336
  s_waitcnt lgkmcnt(3)
  v_mfma_f32_16x16x32_bf16 v[16:19], v[12:15], v[88:91], v[16:19]
  v_dot2_f32_bf16 v20, v88, v88, v20
  v_dot2_f32_bf16 v21, v89, v89, v21
  v_dot2_f32_bf16 v22, v90, v90, v22
  v_dot2_f32_bf16 v23, v91, v91, v23
  ds_read_b128 v[88:91], v1 offset:15360
  s_waitcnt lgkmcnt(3)
  v_mfma_f32_16x16x32_bf16 v[16:19], v[12:15], v[76:79], v[16:19]
  v_dot2_f32_bf16 v20, v76, v76, v20
  v_dot2_f32_bf16 v21, v77, v77, v21
  v_dot2_f32_bf16 v22, v78, v78, v22
  v_dot2_f32_bf16 v23, v79, v79, v23
  ds_read_b128 v[76:79], v1 offset:16384
  s_waitcnt lgkmcnt(3)
  v_mfma_f32_16x16x32_bf16 v[16:19], v[12:15], v[80:83], v[16:19]
  v_dot2_f32_bf16 v20, v80, v80, v20
  v_dot2_f32_bf16 v21, v81, v81, v21
  v_dot2_f32_bf16 v22, v82, v82, v22
  v_dot2_f32_bf16 v23, v83, v83, v23
  ds_read_b128 v[80:83], v1 offset:17408
  s_waitcnt lgkmcnt(3)
  v_mfma_f32_16x16x32_bf16 v[16:19], v[12:15], v[84:87], v[16:19]
  v_dot2_f32_bf16 v20, v84, v84, v20
  v_dot2_f32_bf16 v21, v85, v85, v21
  v_dot2_f32_bf16 v22, v86, v86, v22
  v_dot2_f32_bf16 v23, v87, v87, v23
  ds_read_b128 v[84:87], v1 offset:18432
  s_waitcnt lgkmcnt(3)
  v_mfma_f32_16x16x32_bf16 v[16:19], v[12:15], v[88:91], v[16:19]
  v_dot2_f32_bf16 v20, v88, v88, v20
  v_dot2_f32_bf16 v21, v89, v89, v21
  v_dot2_f32_bf16 v22, v90, v90, v22
  v_dot2_f32_bf16 v23, v91, v91, v23
  ds_read_b128 v[88:91], v1 offset:19456
  s_waitcnt lgkmcnt(3)
  v_mfma_f32_16x16x32_bf16 v[16:19], v[12:15], v[76:79], v[16:19]
  v_dot2_f32_bf16 v20, v76, v76, v20
  v_dot2_f32_bf16 v21, v77, v77, v21
  v_dot2_f32_bf16 v22, v78, v78, v22
  v_dot2_f32_bf16 v23, v79, v79, v23
  ds_read_b128 v[76:79], v1 offset:20480
  s_waitcnt lgkmcnt(3)
  v_mfma_f32_16x16x32_bf16 v[16:19], v[12:15], v[80:83], v[16:19]
  v_dot2_f32_bf16 v20, v80, v80, v20
  v_dot2_f32_bf16 v21, v81, v81, v21
  v_dot2_f32_bf16 v22, v82, v82, v22
  v_dot2_f32_bf16 v23, v83, v83, v23
  ds_read_b128 v[80:83], v1 offset:21504
  s_waitcnt lgkmcnt(3)
  v_mfma_f32_16x16x32_bf16 v[16:19], v[12:15], v[84:87], v[16:19]
  v_dot2_f32_bf16 v20, v84, v84, v20
  v_dot2_f32_bf16 v21, v85, v85, v21
  v_dot2_f32_bf16 v22, v86, v86, v22
  v_dot2_f32_bf16 v23, v87, v87, v23
  ds_read_b128 v[84:87], v1 offset:22528
  s_waitcnt lgkmcnt(3)
  v_mfma_f32_16x16x32_bf16 v[16:19], v[12:15], v[88:91], v[16:19]
  v_dot2_f32_bf16 v20, v88, v88, v20
  v_dot2_f32_bf16 v21, v89, v89, v21
  v_dot2_f32_bf16 v22, v90, v90, v22
  v_dot2_f32_bf16 v23, v91, v91, v23
  ds_read_b128 v[88:91], v1 offset:23552
  s_waitcnt lgkmcnt(3)
  v_mfma_f32_16x16x32_bf16 v[16:19], v[12:15], v[76:79], v[16:19]
  v_dot2_f32_bf16 v20, v76, v76, v20
  v_dot2_f32_bf16 v21, v77, v77, v21
  v_dot2_f32_bf16 v22, v78, v78, v22
  v_dot2_f32_bf16 v23, v79, v79, v23
  ds_read_b128 v[76:79], v1 offset:24576
  s_waitcnt lgkmcnt(3)
  v_mfma_f32_16x16x32_bf16 v[16:19], v[12:15], v[80:83], v[16:19]
  v_dot2_f32_bf16 v20, v80, v80, v20
  v_dot2_f32_bf16 v21, v81, v81, v21
  v_dot2_f32_bf16 v22, v82, v82, v22
  v_dot2_f32_bf16 v23, v83, v83, v23
  ds_read_b128 v[80:83], v1 offset:25600
  s_waitcnt lgkmcnt(3)
  v_mfma_f32_16x16x32_bf16 v[16:19], v[12:15], v[84:87], v[16:19]
  v_dot2_f32_bf16 v20, v84, v84, v20
  v_dot2_f32_bf16 v21, v85, v85, v21
  v_dot2_f32_bf16 v22, v86, v86, v22
  v_dot2_f32_bf16 v23, v87, v87, v23
  ds_read_b128 v[84:87], v1 offset:26624
  s_waitcnt lgkmcnt(3)
  v_mfma_f32_16x16x32_bf16 v[16:19], v[12:15], v[88:91], v[16:19]
  v_dot2_f32_bf16 v20, v88, v88, v20
  v_dot2_f32_bf16 v21, v89, v89, v21
  v_dot2_f32_bf16 v22, v90, v90, v22
  v_dot2_f32_bf16 v23, v91, v91, v23
  ds_read_b128 v[88:91], v1 offset:27648
  s_waitcnt lgkmcnt(3)
  v_mfma_f32_16x16x32_bf16 v[16:19], v[12:15], v[76:79], v[16:19]
  v_dot2_f32_bf16 v20, v76, v76, v20
  v_dot2_f32_bf16 v21, v77, v77, v21
  v_dot2_f32_bf16 v22, v78, v78, v22
  v_dot2_f32_bf16 v23, v79, v79, v23
  ds_read_b128 v[76:79], v1 offset:28672
  s_waitcnt lgkmcnt(3)
  v_mfma_f32_16x16x32_bf16 v[16:19], v[12:15], v[80:83], v[16:19]
  v_dot2_f32_bf16 v20, v80, v80, v20
  v_dot2_f32_bf16 v21, v81, v81, v21
  v_dot2_f32_bf16 v22, v82, v82, v22
  v_dot2_f32_bf16 v23, v83, v83, v23
  ds_read_b128 v[80:83], v1 offset:29696
  s_waitcnt lgkmcnt(3)
  v_mfma_f32_16x16x32_bf16 v[16:19], v[12:15], v[84:87], v[16:19]
  v_dot2_f32_bf16 v20, v84, v84, v20
  v_dot2_f32_bf16 v21, v85, v85, v21
  v_dot2_f32_bf16 v22, v86, v86, v22
  v_dot2_f32_bf16 v23, v87, v87, v23
  ds_read_b128 v[84:87], v1 offset:30720
  s_waitcnt lgkmcnt(3)
  v_mfma_f32_16x16x32_bf16 v[16:19], v[12:15], v[88:91], v[16:19]
  v_dot2_f32_bf16 v20, v88, v88, v20
  v_dot2_f32_bf16 v21, v89, v89, v21
  v_dot2_f32_bf16 v22, v90, v90, v22
  v_dot2_f32_bf16 v23, v91, v91, v23
  ds_read_b128 v[88:91], v1 offset:31744
  s_waitcnt lgkmcnt(3)
  v_mfma_f32_16x16x32_bf16 v[16:19], v[12:15], v[76:79], v[16:19]
  v_dot2_f32_bf16 v20, v76, v76, v20
  v_dot2_f32_bf16 v21, v77, v77, v21
  v_dot2_f32_bf16 v22, v78, v78, v22
  v_dot2_f32_bf16 v23, v79, v79, v23
  s_waitcnt lgkmcnt(2)
  v_mfma_f32_16x16x32_bf16 v[16:19], v[12:15], v[80:83], v[16:19]
  v_dot2_f32_bf16 v20, v80, v80, v20
  v_dot2_f32_bf16 v21, v81, v81, v21
  v_dot2_f32_bf16 v22, v82, v82, v22
  v_dot2_f32_bf16 v23, v83, v83, v23
  s_waitcnt lgkmcnt(1)
  v_mfma_f32_16x16x32_bf16 v[16:19], v[12:15], v[84:87], v[16:19]
  v_dot2_f32_bf16 v20, v84, v84, v20
  v_dot2_f32_bf16 v21, v85, v85, v21
  v_dot2_f32_bf16 v22, v86, v86, v22
  v_dot2_f32_bf16 v23, v87, v87, v23
  s_waitcnt lgkmcnt(0)
  v_mfma_f32_16x16x32_bf16 v[16:19], v[12:15], v[88:91], v[16:19]
  v_dot2_f32_bf16 v20, v88, v88, v20
  v_dot2_f32_bf16 v21, v89, v89, v21
  v_dot2_f32_bf16 v22, v90, v90, v22
  v_dot2_f32_bf16 v23, v91, v91, v23
  s_nop 0
  v_add_f32 v20, v20, v21
  s_nop 0
  v_add_f32 v22, v22, v23
  v_add_f32 v20, v20, v22
  v_mov_b32 v21, v20
  v_mul_f32 v60, 0x3b000000, v16
  s_nop 0
  v_permlane32_swap_b32 v20, v21
  v_add_f32 v20, v20, v21
  v_mul_f32 v61, v60, v60
  v_mov_b32 v62, 0x3b000000
  v_fma_f32 v61, v20, v62, -v61
  v_max_f32 v61, 0, v61
  v_add_f32 v61, 0x3727c5ac, v61
  v_rsq_f32 v63, v61
  v_mul_f32 v60, -0.5, v60
  v_cvt_pk_bf16_f32 v61, v60, v60
  v_and_b32 v61, 0xffff0000, v61
  v_sub_f32 v61, v60, v61
  v_cvt_pk_bf16_f32 v61, v60, v61
  ds_write_b32 v6, v61 offset:0
  ds_write_b32 v6, v63 offset:256
  s_waitcnt vmcnt(0)
  s_waitcnt lgkmcnt(0)
  s_barrier
  v_mov_b32 v20, 0
  v_mov_b32 v21, 0
  v_mov_b32 v22, 0
  v_mov_b32 v23, 0
  ds_read_b128 v[76:79], v1 offset:32768
  ds_read_b128 v[80:83], v1 offset:33792
  ds_read_b128 v[84:87], v1 offset:34816
  ds_read_b128 v[88:91], v1 offset:35840
  s_waitcnt lgkmcnt(3)
  v_mfma_f32_16x16x32_bf16 v[16:19], v[12:15], v[76:79], 0
  v_dot2_f32_bf16 v20, v76, v76, v20
  v_dot2_f32_bf16 v21, v77, v77, v21
  v_dot2_f32_bf16 v22, v78, v78, v22
  v_dot2_f32_bf16 v23, v79, v79, v23
  ds_read_b128 v[76:79], v1 offset:36864
  s_waitcnt lgkmcnt(3)
  v_mfma_f32_16x16x32_bf16 v[16:19], v[12:15], v[80:83], v[16:19]
  v_dot2_f32_bf16 v20, v80, v80, v20
  v_dot2_f32_bf16 v21, v81, v81, v21
  v_dot2_f32_bf16 v22, v82, v82, v22
  v_dot2_f32_bf16 v23, v83, v83, v23
  ds_read_b128 v[80:83], v1 offset:37888
  s_waitcnt lgkmcnt(3)
  v_mfma_f32_16x16x32_bf16 v[16:19], v[12:15], v[84:87], v[16:19]
  v_dot2_f32_bf16 v20, v84, v84, v20
  v_dot2_f32_bf16 v21, v85, v85, v21
  v_dot2_f32_bf16 v22, v86, v86, v22
  v_dot2_f32_bf16 v23, v87, v87, v23
  ds_read_b128 v[84:87], v1 offset:38912
  s_waitcnt lgkmcnt(3)
  v_mfma_f32_16x16x32_bf16 v[16:19], v[12:15], v[88:91], v[16:19]
  v_dot2_f32_bf16 v20, v88, v88, v20
  v_dot2_f32_bf16 v21, v89, v89, v21
  v_dot2_f32_bf16 v22, v90, v90, v22
  v_dot2_f32_bf16 v23, v91, v91, v23
  ds_read_b128 v[88:91], v1 offset:39936
  s_waitcnt lgkmcnt(3)
  v_mfma_f32_16x16x32_bf16 v[16:19], v[12:15], v[76:79], v[16:19]
  v_dot2_f32_bf16 v20, v76, v76, v20
  v_dot2_f32_bf16 v21, v77, v77, v21
  v_dot2_f32_bf16 v22, v78, v78, v22
  v_dot2_f32_bf16 v23, v79, v79, v23
  ds_read_b128 v[76:79], v1 offset:40960
  s_waitcnt lgkmcnt(3)
  v_mfma_f32_16x16x32_bf16 v[16:19], v[12:15], v[80:83], v[16:19]
  v_dot2_f32_bf16 v20, v80, v80, v20
  v_dot2_f32_bf16 v21, v81, v81, v21
  v_dot2_f32_bf16 v22, v82, v82, v22
  v_dot2_f32_bf16 v23, v83, v83, v23
  ds_read_b128 v[80:83], v1 offset:41984
  s_waitcnt lgkmcnt(3)
  v_mfma_f32_16x16x32_bf16 v[16:19], v[12:15], v[84:87], v[16:19]
  v_dot2_f32_bf16 v20, v84, v84, v20
  v_dot2_f32_bf16 v21, v85, v85, v21
  v_dot2_f32_bf16 v22, v86, v86, v22
  v_dot2_f32_bf16 v23, v87, v87, v23
  ds_read_b128 v[84:87], v1 offset:43008
  s_waitcnt lgkmcnt(3)
  v_mfma_f32_16x16x32_bf16 v[16:19], v[12:15], v[88:91], v[16:19]
  v_dot2_f32_bf16 v20, v88, v88, v20
  v_dot2_f32_bf16 v21, v89, v89, v21
  v_dot2_f32_bf16 v22, v90, v90, v22
  v_dot2_f32_bf16 v23, v91, v91, v23
  ds_read_b128 v[88:91], v1 offset:44032
  s_waitcnt lgkmcnt(3)
  v_mfma_f32_16x16x32_bf16 v[16:19], v[12:15], v[76:79], v[16:19]
  v_dot2_f32_bf16 v20, v76, v76, v20
  v_dot2_f32_bf16 v21, v77, v77, v21
  v_dot2_f32_bf16 v22, v78, v78, v22
  v_dot2_f32_bf16 v23, v79, v79, v23
  ds_read_b128 v[76:79], v1 offset:45056
  s_waitcnt lgkmcnt(3)
  v_mfma_f32_16x16x32_bf16 v[16:19], v[12:15], v[80:83], v[16:19]
  v_dot2_f32_bf16 v20, v80, v80, v20
  v_dot2_f32_bf16 v21, v81, v81, v21
  v_dot2_f32_bf16 v22, v82, v82, v22
  v_dot2_f32_bf16 v23, v83, v83, v23
  ds_read_b128 v[80:83], v1 offset:46080
  s_waitcnt lgkmcnt(3)
  v_mfma_f32_16x16x32_bf16 v[16:19], v[12:15], v[84:87], v[16:19]
  v_dot2_f32_bf16 v20, v84, v84, v20
  v_dot2_f32_bf16 v21, v85, v85, v21
  v_dot2_f32_bf16 v22, v86, v86, v22
  v_dot2_f32_bf16 v23, v87, v87, v23
  ds_read_b128 v[84:87], v1 offset:47104
  s_waitcnt lgkmcnt(3)
  v_mfma_f32_16x16x32_bf16 v[16:19], v[12:15], v[88:91], v[16:19]
  v_dot2_f32_bf16 v20, v88, v88, v20
  v_dot2_f32_bf16 v21, v89, v89, v21
  v_dot2_f32_bf16 v22, v90, v90, v22
  v_dot2_f32_bf16 v23, v91, v91, v23
  ds_read_b128 v[88:91], v1 offset:48128
  s_waitcnt lgkmcnt(3)
  v_mfma_f32_16x16x32_bf16 v[16:19], v[12:15], v[76:79], v[16:19]
  v_dot2_f32_bf16 v20, v76, v76, v20
  v_dot2_f32_bf16 v21, v77, v77, v21
  v_dot2_f32_bf16 v22, v78, v78, v22
  v_dot2_f32_bf16 v23, v79, v79, v23
  ds_read_b128 v[76:79], v1 offset:49152
  s_waitcnt lgkmcnt(3)
  v_mfma_f32_16x16x32_bf16 v[16:19], v[12:15], v[80:83], v[16:19]
  v_dot2_f32_bf16 v20, v80, v80, v20
  v_dot2_f32_bf16 v21, v81, v81, v21
  v_dot2_f32_bf16 v22, v82, v82, v22
  v_dot2_f32_bf16 v23, v83, v83, v23
  ds_read_b128 v[80:83], v1 offset:50176
  s_waitcnt lgkmcnt(3)
  v_mfma_f32_16x16x32_bf16 v[16:19], v[12:15], v[84:87], v[16:19]
  v_dot2_f32_bf16 v20, v84, v84, v20
  v_dot2_f32_bf16 v21, v85, v85, v21
  v_dot2_f32_bf16 v22, v86, v86, v22
  v_dot2_f32_bf16 v23, v87, v87, v23
  ds_read_b128 v[84:87], v1 offset:51200
  s_waitcnt lgkmcnt(3)
  v_mfma_f32_16x16x32_bf16 v[16:19], v[12:15], v[88:91], v[16:19]
  v_dot2_f32_bf16 v20, v88, v88, v20
  v_dot2_f32_bf16 v21, v89, v89, v21
  v_dot2_f32_bf16 v22, v90, v90, v22
  v_dot2_f32_bf16 v23, v91, v91, v23
  ds_read_b128 v[88:91], v1 offset:52224
  s_waitcnt lgkmcnt(3)
  v_mfma_f32_16x16x32_bf16 v[16:19], v[12:15], v[76:79], v[16:19]
  v_dot2_f32_bf16 v20, v76, v76, v20
  v_dot2_f32_bf16 v21, v77, v77, v21
  v_dot2_f32_bf16 v22, v78, v78, v22
  v_dot2_f32_bf16 v23, v79, v79, v23
  ds_read_b128 v[76:79], v1 offset:53248
  s_waitcnt lgkmcnt(3)
  v_mfma_f32_16x16x32_bf16 v[16:19], v[12:15], v[80:83], v[16:19]
  v_dot2_f32_bf16 v20, v80, v80, v20
  v_dot2_f32_bf16 v21, v81, v81, v21
  v_dot2_f32_bf16 v22, v82, v82, v22
  v_dot2_f32_bf16 v23, v83, v83, v23
  ds_read_b128 v[80:83], v1 offset:54272
  s_waitcnt lgkmcnt(3)
  v_mfma_f32_16x16x32_bf16 v[16:19], v[12:15], v[84:87], v[16:19]
  v_dot2_f32_bf16 v20, v84, v84, v20
  v_dot2_f32_bf16 v21, v85, v85, v21
  v_dot2_f32_bf16 v22, v86, v86, v22
  v_dot2_f32_bf16 v23, v87, v87, v23
  ds_read_b128 v[84:87], v1 offset:55296
  s_waitcnt lgkmcnt(3)
  v_mfma_f32_16x16x32_bf16 v[16:19], v[12:15], v[88:91], v[16:19]
  v_dot2_f32_bf16 v20, v88, v88, v20
  v_dot2_f32_bf16 v21, v89, v89, v21
  v_dot2_f32_bf16 v22, v90, v90, v22
  v_dot2_f32_bf16 v23, v91, v91, v23
  ds_read_b128 v[88:91], v1 offset:56320
  s_waitcnt lgkmcnt(3)
  v_mfma_f32_16x16x32_bf16 v[16:19], v[12:15], v[76:79], v[16:19]
  v_dot2_f32_bf16 v20, v76, v76, v20
  v_dot2_f32_bf16 v21, v77, v77, v21
  v_dot2_f32_bf16 v22, v78, v78, v22
  v_dot2_f32_bf16 v23, v79, v79, v23
  ds_read_b128 v[76:79], v1 offset:57344
  s_waitcnt lgkmcnt(3)
  v_mfma_f32_16x16x32_bf16 v[16:19], v[12:15], v[80:83], v[16:19]
  v_dot2_f32_bf16 v20, v80, v80, v20
  v_dot2_f32_bf16 v21, v81, v81, v21
  v_dot2_f32_bf16 v22, v82, v82, v22
  v_dot2_f32_bf16 v23, v83, v83, v23
  ds_read_b128 v[80:83], v1 offset:58368
  s_waitcnt lgkmcnt(3)
  v_mfma_f32_16x16x32_bf16 v[16:19], v[12:15], v[84:87], v[16:19]
  v_dot2_f32_bf16 v20, v84, v84, v20
  v_dot2_f32_bf16 v21, v85, v85, v21
  v_dot2_f32_bf16 v22, v86, v86, v22
  v_dot2_f32_bf16 v23, v87, v87, v23
  ds_read_b128 v[84:87], v1 offset:59392
  s_waitcnt lgkmcnt(3)
  v_mfma_f32_16x16x32_bf16 v[16:19], v[12:15], v[88:91], v[16:19]
  v_dot2_f32_bf16 v20, v88, v88, v20
  v_dot2_f32_bf16 v21, v89, v89, v21
  v_dot2_f32_bf16 v22, v90, v90, v22
  v_dot2_f32_bf16 v23, v91, v91, v23
  ds_read_b128 v[88:91], v1 offset:60416
  s_waitcnt lgkmcnt(3)
  v_mfma_f32_16x16x32_bf16 v[16:19], v[12:15], v[76:79], v[16:19]
  v_dot2_f32_bf16 v20, v76, v76, v20
  v_dot2_f32_bf16 v21, v77, v77, v21
  v_dot2_f32_bf16 v22, v78, v78, v22
  v_dot2_f32_bf16 v23, v79, v79, v23
  ds_read_b128 v[76:79], v1 offset:61440
  s_waitcnt lgkmcnt(3)
  v_mfma_f32_16x16x32_bf16 v[16:19], v[12:15], v[80:83], v[16:19]
  v_dot2_f32_bf16 v20, v80, v80, v20
  v_dot2_f32_bf16 v21, v81, v81, v21
  v_dot2_f32_bf16 v22, v82, v82, v22
  v_dot2_f32_bf16 v23, v83, v83, v23
  ds_read_b128 v[80:83], v1 offset:62464
  s_waitcnt lgkmcnt(3)
  v_mfma_f32_16x16x32_bf16 v[16:19], v[12:15], v[84:87], v[16:19]
  v_dot2_f32_bf16 v20, v84, v84, v20
  v_dot2_f32_bf16 v21, v85, v85, v21
  v_dot2_f32_bf16 v22, v86, v86, v22
  v_dot2_f32_bf16 v23, v87, v87, v23
  ds_read_b128 v[84:87], v1 offset:63488
  s_waitcnt lgkmcnt(3)
  v_mfma_f32_16x16x32_bf16 v[16:19], v[12:15], v[88:91], v[16:19]
  v_dot2_f32_bf16 v20, v88, v88, v20
  v_dot2_f32_bf16 v21, v89, v89, v21
  v_dot2_f32_bf16 v22, v90, v90, v22
  v_dot2_f32_bf16 v23, v91, v91, v23
  ds_read_b128 v[88:91], v1 offset:64512
  s_waitcnt lgkmcnt(3)
  v_mfma_f32_16x16x32_bf16 v[16:19], v[12:15], v[76:79], v[16:19]
  v_dot2_f32_bf16 v20, v76, v76, v20
  v_dot2_f32_bf16 v21, v77, v77, v21
  v_dot2_f32_bf16 v22, v78, v78, v22
  v_dot2_f32_bf16 v23, v79, v79, v23
  s_waitcnt lgkmcnt(2)
  v_mfma_f32_16x16x32_bf16 v[16:19], v[12:15], v[80:83], v[16:19]
  v_dot2_f32_bf16 v20, v80, v80, v20
  v_dot2_f32_bf16 v21, v81, v81, v21
  v_dot2_f32_bf16 v22, v82, v82, v22
  v_dot2_f32_bf16 v23, v83, v83, v23
  s_waitcnt lgkmcnt(1)
  v_mfma_f32_16x16x32_bf16 v[16:19], v[12:15], v[84:87], v[16:19]
  v_dot2_f32_bf16 v20, v84, v84, v20
  v_dot2_f32_bf16 v21, v85, v85, v21
  v_dot2_f32_bf16 v22, v86, v86, v22
  v_dot2_f32_bf16 v23, v87, v87, v23
  s_waitcnt lgkmcnt(0)
  v_mfma_f32_16x16x32_bf16 v[16:19], v[12:15], v[88:91], v[16:19]
  v_dot2_f32_bf16 v20, v88, v88, v20
  v_dot2_f32_bf16 v21, v89, v89, v21
  v_dot2_f32_bf16 v22, v90, v90, v22
  v_dot2_f32_bf16 v23, v91, v91, v23
  s_nop 0
  v_add_f32 v20, v20, v21
  s_nop 0
  v_add_f32 v22, v22, v23
  v_add_f32 v20, v20, v22
  v_mov_b32 v21, v20
  v_mul_f32 v60, 0x3b000000, v16
  s_nop 0
  v_permlane32_swap_b32 v20, v21
  v_add_f32 v20, v20, v21
  v_mul_f32 v61, v60, v60
  v_mov_b32 v62, 0x3b000000
  v_fma_f32 v61, v20, v62, -v61
  v_max_f32 v61, 0, v61
  v_add_f32 v61, 0x3727c5ac, v61
  v_rsq_f32 v63, v61
  v_mul_f32 v60, -0.5, v60
  v_cvt_pk_bf16_f32 v61, v60, v60
  v_and_b32 v61, 0xffff0000, v61
  v_sub_f32 v61, v60, v61
  v_cvt_pk_bf16_f32 v61, v60, v61
  ds_write_b32 v6, v61 offset:128
  ds_write_b32 v6, v63 offset:384
  buffer_load_dword v26, v0, s[8:11], s62 offen sc1
  s_waitcnt lgkmcnt(0)
  s_setprio 0
  s_waitcnt vmcnt(0)
  v_cmp_eq_u32 vcc, s51, v26
  s_cmp_eq_u64 vcc, -1
  s_cbranch_scc0 k6_kernel_pq35
k6_kernel_pr36:
  buffer_load_dwordx4 v[92:95], v1, s[8:11], s74 offen offset:0 sc1
  buffer_load_dwordx4 v[96:99], v1, s[8:11], s74 offen offset:1024 sc1
  buffer_load_dwordx4 v[100:103], v1, s[8:11], s74 offen offset:2048 sc1
  buffer_load_dwordx4 v[104:107], v1, s[8:11], s74 offen offset:3072 sc1
  s_add_u32 s74, s74, 0x1000
  buffer_load_dwordx4 v[108:111], v1, s[8:11], s74 offen offset:0 sc1
  buffer_load_dwordx4 v[112:115], v1, s[8:11], s74 offen offset:1024 sc1
  buffer_load_dwordx4 v[116:119], v1, s[8:11], s74 offen offset:2048 sc1
  buffer_load_dwordx4 v[120:123], v1, s[8:11], s74 offen offset:3072 sc1
  s_add_u32 s74, s74, 0x1000
  buffer_load_dwordx4 v[28:31], v1, s[8:11], s74 offen offset:0 sc1
  buffer_load_dwordx4 v[32:35], v1, s[8:11], s74 offen offset:1024 sc1
  buffer_load_dwordx4 v[36:39], v1, s[8:11], s74 offen offset:2048 sc1
  buffer_load_dwordx4 v[40:43], v1, s[8:11], s74 offen offset:3072 sc1
  s_add_u32 s74, s74, 0x1000
  buffer_load_dwordx4 v[44:47], v1, s[8:11], s74 offen offset:0 sc1
  buffer_load_dwordx4 v[48:51], v1, s[8:11], s74 offen offset:1024 sc1
  s_barrier
  s_waitcnt vmcnt(13)
  v_mfma_f32_32x32x16_bf16 v[60:75], v[124:127], v[92:95], 0
  v_mfma_f32_32x32x16_bf16 v[12:27], v[128:131], v[92:95], 0
  s_waitcnt vmcnt(12)
  v_mfma_f32_32x32x16_bf16 v[60:75], v[132:135], v[96:99], v[60:75]
  v_mfma_f32_32x32x16_bf16 v[12:27], v[136:139], v[96:99], v[12:27]
  s_waitcnt vmcnt(11)
  v_mfma_f32_32x32x16_bf16 v[60:75], v[140:143], v[100:103], v[60:75]
  v_mfma_f32_32x32x16_bf16 v[12:27], v[144:147], v[100:103], v[12:27]
  v_lshrrev_b32 v11, 10, v9
  v_bfe_u32 v3, v9, 3, 1
  v_lshl_add_u32 v3, v3, 5, v11
  v_lshlrev_b32 v3, 4, v3
  v_and_b32 v52, 16, v9
  v_lshrrev_b32 v52, 1, v52
  v_add_u32 v3, v3, v52
  v_and_b32 v52, 0x60, v9
  v_lshl_add_u32 v3, v52, 5, v3
  s_lshl_b32 s7, s66, 1
  s_sub_u32 s7, s67, s7
  s_and_b32 s7, s7, 7
  s_lshl_b32 s7, s7, 12
  v_add_u32 v3, s7, v3
  v_lshlrev_b32 v11, 2, v11
  v_add_u32 v11, 0x24e00, v11
  ds_read_b64 v[52:53], v3
  ds_read_b64 v[54:55], v3 offset:32768
  ds_read2_b32 v[56:57], v11 offset0:0 offset1:32
  s_waitcnt vmcnt(10)
  v_mfma_f32_32x32x16_bf16 v[60:75], v[148:151], v[104:107], v[60:75]
  v_mfma_f32_32x32x16_bf16 v[12:27], v[152:155], v[104:107], v[12:27]
  s_waitcnt vmcnt(9)
  v_mfma_f32_32x32x16_bf16 v[60:75], v[156:159], v[108:111], v[60:75]
  v_mfma_f32_32x32x16_bf16 v[12:27], v[160:163], v[108:111], v[12:27]
  s_waitcnt vmcnt(8)
  v_mfma_f32_32x32x16_bf16 v[60:75], v[164:167], v[112:115], v[60:75]
  v_mfma_f32_32x32x16_bf16 v[12:27], v[168:171], v[112:115], v[12:27]
  s_waitcnt vmcnt(7)
  v_mfma_f32_32x32x16_bf16 v[60:75], v[172:175], v[116:119], v[60:75]
  v_mfma_f32_32x32x16_bf16 v[12:27], v[176:179], v[116:119], v[12:27]
  s_waitcnt vmcnt(6)
  v_mfma_f32_32x32x16_bf16 v[60:75], v[180:183], v[120:123], v[60:75]
  v_mfma_f32_32x32x16_bf16 v[12:27], v[184:187], v[120:123], v[12:27]
  s_add_u32 s62, s62, 0x4000
  buffer_load_dword v252, v0, s[8:11], s62 offen sc1
  s_waitcnt vmcnt(6)
  v_mfma_f32_32x32x16_bf16 v[60:75], v[188:191], v[28:31], v[60:75]
  v_mfma_f32_32x32x16_bf16 v[12:27], v[192:195], v[28:31], v[12:27]
  s_waitcnt lgkmcnt(0)
  s_barrier
  s_waitcnt vmcnt(5)
  v_mfma_f32_32x32x16_bf16 v[60:75], v[196:199], v[32:35], v[60:75]
  v_mfma_f32_32x32x16_bf16 v[12:27], v[200:203], v[32:35], v[12:27]
  s_waitcnt vmcnt(4)
  v_mfma_f32_32x32x16_bf16 v[60:75], v[204:207], v[36:39], v[60:75]
  v_mfma_f32_32x32x16_bf16 v[12:27], v[208:211], v[36:39], v[12:27]
  s_waitcnt vmcnt(0)
  v_cmp_eq_u32 vcc, s51, v252
  s_cmp_eq_u64 vcc, -1
  s_cbranch_scc0 k6_kernel_pq37
k6_kernel_pr38:
  s_add_u32 s74, s74, 0x19000
  buffer_load_dwordx4 v[92:95], v1, s[8:11], s74 offen offset:0 sc1
  buffer_load_dwordx4 v[96:99], v1, s[8:11], s74 offen offset:1024 sc1
  buffer_load_dwordx4 v[100:103], v1, s[8:11], s74 offen offset:2048 sc1
  buffer_load_dwordx4 v[104:107], v1, s[8:11], s74 offen offset:3072 sc1
  v_mfma_f32_32x32x16_bf16 v[60:75], v[212:215], v[40:43], v[60:75]
  v_mfma_f32_32x32x16_bf16 v[12:27], v[216:219], v[40:43], v[12:27]
  s_add_u32 s74, s74, 0x1000
  buffer_load_dwordx4 v[108:111], v1, s[8:11], s74 offen offset:0 sc1
  v_mfma_f32_32x32x16_bf16 v[60:75], v[220:223], v[44:47], v[60:75]
  v_mfma_f32_32x32x16_bf16 v[12:27], v[224:227], v[44:47], v[12:27]
  buffer_load_dwordx4 v[112:115], v1, s[8:11], s74 offen offset:1024 sc1
  v_mfma_f32_32x32x16_bf16 v[60:75], v[228:231], v[48:51], v[60:75]
  v_mfma_f32_32x32x16_bf16 v[12:27], v[232:235], v[48:51], v[12:27]
  buffer_load_dwordx4 v[116:119], v1, s[8:11], s74 offen offset:2048 sc1
  s_waitcnt vmcnt(6)
  v_mfma_f32_32x32x16_bf16 v[236:251], v[124:127], v[92:95], 0
  v_mfma_f32_32x32x16_bf16 v[76:91], v[128:131], v[92:95], 0
  buffer_load_dwordx4 v[120:123], v1, s[8:11], s74 offen offset:3072 sc1
  s_nop 5
  ds_write_b128 v7, v[60:63] offset:2112
  ds_write_b128 v7, v[64:67] offset:3168
  ds_write_b128 v7, v[68:71] offset:0
  ds_write_b128 v7, v[72:75] offset:1056
  s_waitcnt vmcnt(6)
  v_mfma_f32_32x32x16_bf16 v[236:251], v[132:135], v[96:99], v[236:251]
  v_mfma_f32_32x32x16_bf16 v[76:91], v[136:139], v[96:99], v[76:91]
  s_add_u32 s74, s74, 0x1000
  buffer_load_dwordx4 v[28:31], v1, s[8:11], s74 offen offset:0 sc1
  ds_write_b128 v7, v[12:15] offset:6336
  ds_write_b128 v7, v[16:19] offset:7392
  ds_write_b128 v7, v[20:23] offset:4224
  ds_write_b128 v7, v[24:27] offset:5280
  s_waitcnt vmcnt(6)
  v_mfma_f32_32x32x16_bf16 v[236:251], v[140:143], v[100:103], v[236:251]
  v_mfma_f32_32x32x16_bf16 v[76:91], v[144:147], v[100:103], v[76:91]
  buffer_load_dwordx4 v[32:35], v1, s[8:11], s74 offen offset:1024 sc1
  s_waitcnt vmcnt(6)
  v_mfma_f32_32x32x16_bf16 v[236:251], v[148:151], v[104:107], v[236:251]
  v_mfma_f32_32x32x16_bf16 v[76:91], v[152:155], v[104:107], v[76:91]
  buffer_load_dwordx4 v[36:39], v1, s[8:11], s74 offen offset:2048 sc1
  s_waitcnt vmcnt(6)
  v_mfma_f32_32x32x16_bf16 v[236:251], v[156:159], v[108:111], v[236:251]
  v_mfma_f32_32x32x16_bf16 v[76:91], v[160:163], v[108:111], v[76:91]
  buffer_load_dwordx4 v[40:43], v1, s[8:11], s74 offen offset:3072 sc1
  s_waitcnt lgkmcnt(0)
  s_barrier
  v_add_u32 v7, 0x14500, v7
  ds_read_b128 v[60:63], v8 offset:0
  ds_read_b128 v[64:67], v8 offset:8448
  ds_read_b128 v[68:71], v8 offset:16896
  ds_read_b128 v[72:75], v8 offset:25344
  ds_read_b128 v[12:15], v8 offset:33792
  ds_read_b128 v[16:19], v8 offset:42240
  ds_read_b128 v[20:23], v8 offset:50688
  ds_read_b128 v[24:27], v8 offset:59136
  s_waitcnt vmcnt(6)
  v_mfma_f32_32x32x16_bf16 v[236:251], v[164:167], v[112:115], v[236:251]
  v_mfma_f32_32x32x16_bf16 v[76:91], v[168:171], v[112:115], v[76:91]
  s_add_u32 s74, s74, 0x1000
  buffer_load_dwordx4 v[44:47], v1, s[8:11], s74 offen offset:0 sc1
  s_waitcnt vmcnt(6)
  v_mfma_f32_32x32x16_bf16 v[236:251], v[172:175], v[116:119], v[236:251]
  v_mfma_f32_32x32x16_bf16 v[76:91], v[176:179], v[116:119], v[76:91]
  buffer_load_dwordx4 v[48:51], v1, s[8:11], s74 offen offset:1024 sc1
  s_waitcnt vmcnt(6)
  v_mfma_f32_32x32x16_bf16 v[236:251], v[180:183], v[120:123], v[236:251]
  v_mfma_f32_32x32x16_bf16 v[76:91], v[184:187], v[120:123], v[76:91]
  s_waitcnt lgkmcnt(6)
  v_pk_add_f32 v[60:61], v[60:61], v[64:65]
  v_pk_add_f32 v[62:63], v[62:63], v[66:67]
  s_waitcnt lgkmcnt(4)
  v_pk_add_f32 v[68:69], v[68:69], v[72:73]
  v_pk_add_f32 v[70:71], v[70:71], v[74:75]
  s_waitcnt lgkmcnt(2)
  v_pk_add_f32 v[12:13], v[12:13], v[16:17]
  v_pk_add_f32 v[14:15], v[14:15], v[18:19]
  s_waitcnt lgkmcnt(0)
  v_pk_add_f32 v[20:21], v[20:21], v[24:25]
  v_pk_add_f32 v[22:23], v[22:23], v[26:27]
  v_pk_add_f32 v[60:61], v[60:61], v[68:69]
  v_pk_add_f32 v[62:63], v[62:63], v[70:71]
  v_pk_add_f32 v[12:13], v[12:13], v[20:21]
  v_pk_add_f32 v[14:15], v[14:15], v[22:23]
  v_pk_add_f32 v[60:61], v[60:61], v[12:13]
  v_pk_add_f32 v[62:63], v[62:63], v[14:15]
  v_lshlrev_b32 v64, 16, v52
  v_and_b32 v65, 0xffff0000, v52
  v_lshlrev_b32 v66, 16, v53
  v_and_b32 v67, 0xffff0000, v53
  v_fma_f32 v64, v60, v56, v64
  v_fma_f32 v65, v61, v56, v65
  v_fma_f32 v66, v62, v56, v66
  v_fma_f32 v67, v63, v56, v67
  v_cvt_pk_bf16_f32 v64, v64, v65
  v_cvt_pk_bf16_f32 v65, v66, v67
  buffer_store_dwordx2 v[64:65], v9, s[28:31], s75 offen
  s_waitcnt vmcnt(6)
  v_mfma_f32_32x32x16_bf16 v[236:251], v[188:191], v[28:31], v[236:251]
  v_mfma_f32_32x32x16_bf16 v[76:91], v[192:195], v[28:31], v[76:91]
  s_waitcnt vmcnt(5)
  v_mfma_f32_32x32x16_bf16 v[236:251], v[196:199], v[32:35], v[236:251]
  v_mfma_f32_32x32x16_bf16 v[76:91], v[200:203], v[32:35], v[76:91]
  s_waitcnt vmcnt(4)
  v_mfma_f32_32x32x16_bf16 v[236:251], v[204:207], v[36:39], v[236:251]
  s_waitcnt vmcnt(3)
  v_mfma_f32_32x32x16_bf16 v[236:251], v[212:215], v[40:43], v[236:251]
  s_waitcnt vmcnt(2)
  v_mfma_f32_32x32x16_bf16 v[236:251], v[220:223], v[44:47], v[236:251]
  s_waitcnt vmcnt(1)
  v_mfma_f32_32x32x16_bf16 v[236:251], v[228:231], v[48:51], v[236:251]
  v_mfma_f32_32x32x16_bf16 v[76:91], v[208:211], v[36:39], v[76:91]
  v_mfma_f32_32x32x16_bf16 v[76:91], v[216:219], v[40:43], v[76:91]
  s_nop 9
  ds_write_b128 v7, v[236:239] offset:2112
  ds_write_b128 v7, v[240:243] offset:3168
  ds_write_b128 v7, v[244:247] offset:0
  ds_write_b128 v7, v[248:251] offset:1056
  v_mfma_f32_32x32x16_bf16 v[76:91], v[224:227], v[44:47], v[76:91]
  v_mfma_f32_32x32x16_bf16 v[76:91], v[232:235], v[48:51], v[76:91]
  s_nop 11
  ds_write_b128 v7, v[76:79] offset:6336
  ds_write_b128 v7, v[80:83] offset:7392
  ds_write_b128 v7, v[84:87] offset:4224
  ds_write_b128 v7, v[88:91] offset:5280
  v_add_u32 v8, 0x14500, v8
  s_waitcnt lgkmcnt(0)
  s_barrier
  ds_read_b128 v[236:239], v8 offset:0
  ds_read_b128 v[240:243], v8 offset:8448
  ds_read_b128 v[244:247], v8 offset:16896
  ds_read_b128 v[248:251], v8 offset:25344
  ds_read_b128 v[76:79], v8 offset:33792
  ds_read_b128 v[80:83], v8 offset:42240
  ds_read_b128 v[84:87], v8 offset:50688
  ds_read_b128 v[88:91], v8 offset:59136
  s_waitcnt lgkmcnt(6)
  v_pk_add_f32 v[236:237], v[236:237], v[240:241]
  v_pk_add_f32 v[238:239], v[238:239], v[242:243]
  s_waitcnt lgkmcnt(4)
  v_pk_add_f32 v[244:245], v[244:245], v[248:249]
  v_pk_add_f32 v[246:247], v[246:247], v[250:251]
  s_waitcnt lgkmcnt(2)
  v_pk_add_f32 v[76:77], v[76:77], v[80:81]
  v_pk_add_f32 v[78:79], v[78:79], v[82:83]
  s_waitcnt lgkmcnt(0)
  v_pk_add_f32 v[84:85], v[84:85], v[88:89]
  v_pk_add_f32 v[86:87], v[86:87], v[90:91]
  v_pk_add_f32 v[236:237], v[236:237], v[244:245]
  v_pk_add_f32 v[238:239], v[238:239], v[246:247]
  v_pk_add_f32 v[76:77], v[76:77], v[84:85]
  v_pk_add_f32 v[78:79], v[78:79], v[86:87]
  v_pk_add_f32 v[236:237], v[236:237], v[76:77]
  v_pk_add_f32 v[238:239], v[238:239], v[78:79]
  v_lshlrev_b32 v240, 16, v54
  v_and_b32 v241, 0xffff0000, v54
  v_lshlrev_b32 v242, 16, v55
  v_and_b32 v243, 0xffff0000, v55
  v_fma_f32 v240, v236, v57, v240
  v_fma_f32 v241, v237, v57, v241
  v_fma_f32 v242, v238, v57, v242
  v_fma_f32 v243, v239, v57, v243
  v_cvt_pk_bf16_f32 v240, v240, v241
  v_cvt_pk_bf16_f32 v241, v242, v243
  s_add_u32 s75, s75, 0x8000
  buffer_store_dwordx2 v[240:241], v9, s[28:31], s75 offen
  s_endpgm
k6_kernel_hp6:
  s_mov_b32 s36, 0
k6_kernel_L38:
  s_add_u32 s36, s36, 1
  buffer_load_dword v28, v248, s[8:11], 0 offen sc1
  s_waitcnt vmcnt(0)
  v_cmp_ne_u32 vcc, v249, v28
  s_cmp_eq_u64 vcc, -1
  s_cbranch_scc1 k6_kernel_np7
  s_and_b32 s42, s36, 15
  s_cbranch_scc1 k6_kernel_L38
  global_load_dword v25, v24, s[4:5] sc1
  s_cmp_gt_u32 s36, 0x30d40
  s_cbranch_scc1 k6_kernel_np7
  s_waitcnt vmcnt(0)
  v_cmp_eq_u32 vcc, s7, v25
  s_cmp_eq_u64 vcc, -1
  s_cbranch_scc0 k6_kernel_L38
  s_branch k6_kernel_np7
k6_kernel_zq8:
  s_mov_b32 s36, 0
k6_kernel_L39:
  global_load_dword v252, v254, s[4:5] sc1
  s_add_u32 s36, s36, 1
  s_cmp_gt_u32 s36, 0x30d40
  s_cbranch_scc1 k6_kernel_zb9
  s_waitcnt vmcnt(0)
  v_cmp_eq_u32 vcc, s7, v252
  s_cmp_eq_u64 vcc, -1
  s_cbranch_scc0 k6_kernel_L39
  s_branch k6_kernel_zb9
k6_kernel_tq10:
  s_mov_b32 s40, 0
k6_kernel_L40:
  v_cmp_ne_u32 vcc, 0, v252
  s_cmp_eq_u64 vcc, -1
  s_cbranch_scc1 k6_kernel_td42
  buffer_load_dword v252, v255, s[8:11], s63 offen sc1
  s_add_u32 s40, s40, 1
  s_cmp_lt_u32 s40, 24
  s_waitcnt vmcnt(0)
  s_cbranch_scc1 k6_kernel_L40
k6_kernel_td42:
  v_cmp_eq_u32 vcc, s53, v252
  s_cmp_eq_u64 vcc, -1
  s_cbranch_scc1 k6_kernel_tb11
  s_mov_b32 s51, 2
  s_mov_b32 s52, 1
  s_mov_b32 s34, 0
  s_branch k6_kernel_tb11
k6_kernel_fb13:
  s_bfe_u32 s7, s54, 0x5000a
  s_lshl_b32 s7, s7, 16
  s_add_u32 s41, s7, 0x200000
  s_add_u32 s36, s41, 0x10000
  v_mov_b32 v0, 0xff800000
k6_kernel_L42:
  buffer_load_dwordx4 v[16:19], v1, s[8:11], s41 offen
  s_add_u32 s41, s41, 0x400
  s_waitcnt vmcnt(0)
  v_mfma_f32_32x32x16_bf16 v[28:43], v[16:19], v[12:15], 0
  s_nop 11
  v_max3_f32 v0, v0, v28, v29
  v_max3_f32 v0, v0, v30, v31
  v_max3_f32 v0, v0, v32, v33
  v_max3_f32 v0, v0, v34, v35
  v_max3_f32 v0, v0, v36, v37
  v_max3_f32 v0, v0, v38, v39
  v_max3_f32 v0, v0, v40, v41
  v_max3_f32 v0, v0, v42, v43
  s_cmp_lg_u32 s41, s36
  s_cbranch_scc1 k6_kernel_L42
  v_mov_b32 v3, v0
  s_add_u32 s41, s7, 0x200000
  s_add_u32 s42, s7, 0x3ffc00
  v_permlane32_swap_b32 v0, v3
  v_max_f32 v0, v0, v3
  v_sub_f32 v76, 0, v0
  v_sub_f32 v77, 0, v0
  v_sub_f32 v78, 0, v0
  v_sub_f32 v79, 0, v0
  v_sub_f32 v80, 0, v0
  v_sub_f32 v81, 0, v0
  v_sub_f32 v82, 0, v0
  v_sub_f32 v83, 0, v0
  v_sub_f32 v84, 0, v0
  v_sub_f32 v85, 0, v0
  v_sub_f32 v86, 0, v0
  v_sub_f32 v87, 0, v0
  v_sub_f32 v88, 0, v0
  v_sub_f32 v89, 0, v0
  v_sub_f32 v90, 0, v0
  v_sub_f32 v91, 0, v0
  v_mov_b32 v60, 0
  v_mov_b32 v61, 0
  v_mov_b32 v62, 0
  v_mov_b32 v63, 0
  v_mov_b32 v64, 0
  v_mov_b32 v65, 0
  v_mov_b32 v66, 0
  v_mov_b32 v67, 0
  v_mov_b32 v68, 0
  v_mov_b32 v69, 0
  v_mov_b32 v70, 0
  v_mov_b32 v71, 0
  v_mov_b32 v72, 0
  v_mov_b32 v73, 0
  v_mov_b32 v74, 0
  v_mov_b32 v75, 0
k6_kernel_L43:
  buffer_load_dwordx4 v[16:19], v1, s[8:11], s41 offen
  s_mov_b32 exec_lo, 0xffff
  s_mov_b32 exec_hi, 0xffff
  buffer_load_dwordx4 v[20:23], v4, s[8:11], s42 offen
  buffer_load_dwordx4 v[24:27], v5, s[8:11], s42 offen
  s_mov_b64 exec, -1
  s_add_u32 s41, s41, 0x400
  s_add_u32 s42, s42, 0x400
  s_waitcnt vmcnt(0)
  v_mfma_f32_32x32x16_bf16 v[28:43], v[16:19], v[12:15], v[76:91]
  s_nop 11
  v_exp_f32 v28, v28
  v_exp_f32 v29, v29
  v_exp_f32 v30, v30
  v_exp_f32 v31, v31
  v_exp_f32 v32, v32
  v_exp_f32 v33, v33
  v_exp_f32 v34, v34
  v_exp_f32 v35, v35
  v_exp_f32 v36, v36
  v_exp_f32 v37, v37
  v_exp_f32 v38, v38
  v_exp_f32 v39, v39
  v_exp_f32 v40, v40
  v_exp_f32 v41, v41
  v_exp_f32 v42, v42
  v_exp_f32 v43, v43
  v_smfmac_f32_32x32x32_bf16 v[60:75], v[20:23], v[28:35], v2
  s_nop 0
  v_smfmac_f32_32x32x32_bf16 v[60:75], v[24:27], v[36:43], v2
  s_cmp_lg_u32 s41, s36
  s_cbranch_scc1 k6_kernel_L43
  s_branch k6_kernel_epi12
k6_kernel_pq16:
  s_mov_b32 s40, 0
k6_kernel_L44:
  buffer_load_dword v88, v89, s[8:11], s59 offen sc1
  s_add_u32 s40, s40, 1
  s_cmp_gt_u32 s40, 0x30d40
  s_cbranch_scc1 k6_kernel_pd46
  s_waitcnt vmcnt(0)
  v_cmp_eq_u32 vcc, v2, v88
  s_cmp_eq_u64 vcc, -1
  s_cbranch_scc0 k6_kernel_L44
k6_kernel_pd46:
  s_cmp_eq_u32 s52, 0
  s_cbranch_scc1 k6_kernel_pr17
  buffer_inv sc1
  s_waitcnt vmcnt(0)
  s_branch k6_kernel_pr17
k6_kernel_pub19:
  buffer_wbl2 sc1
  s_waitcnt vmcnt(0)
  buffer_store_dword v2, off, s[8:11], s60 sc1
  s_branch k6_kernel_pb20
k6_kernel_pq21:
  s_mov_b32 s40, 0
k6_kernel_L46:
  buffer_load_dword v79, v10, s[8:11], s61 offen sc1
  s_add_u32 s40, s40, 1
  s_cmp_gt_u32 s40, 0x30d40
  s_cbranch_scc1 k6_kernel_pd48
  s_waitcnt vmcnt(0)
  v_cmp_eq_u32 vcc, v2, v79
  s_cmp_eq_u64 vcc, -1
  s_cbranch_scc0 k6_kernel_L46
k6_kernel_pd48:
  s_cmp_eq_u32 s52, 0
  s_cbranch_scc1 k6_kernel_pr22
  buffer_inv sc1
  s_waitcnt vmcnt(0)
  s_branch k6_kernel_pr22
k6_kernel_pub23:
  buffer_wbl2 sc1
  s_waitcnt vmcnt(0)
  buffer_store_dword v2, off, s[8:11], s36 sc1
  s_branch k6_kernel_pb24
k6_kernel_pq25:
  s_mov_b32 s40, 0
k6_kernel_L48:
  buffer_load_dword v26, v0, s[8:11], s62 offen sc1
  s_add_u32 s40, s40, 1
  s_cmp_gt_u32 s40, 0x30d40
  s_cbranch_scc1 k6_kernel_pd50
  s_waitcnt vmcnt(0)
  v_cmp_eq_u32 vcc, v2, v26
  s_cmp_eq_u64 vcc, -1
  s_cbranch_scc0 k6_kernel_L48
k6_kernel_pd50:
  s_cmp_eq_u32 s52, 0
  s_cbranch_scc1 k6_kernel_pr26
  buffer_inv sc1
  s_waitcnt vmcnt(0)
  s_branch k6_kernel_pr26
k6_kernel_pub27:
  buffer_wbl2 sc1
  s_waitcnt vmcnt(0)
  buffer_store_dword v2, off, s[8:11], s36 sc1
  s_branch k6_kernel_pb28
k6_kernel_pq29:
  s_mov_b32 s40, 0
k6_kernel_L50:
  buffer_load_dword v252, v0, s[8:11], s62 offen sc1
  s_add_u32 s40, s40, 1
  s_cmp_gt_u32 s40, 0x30d40
  s_cbranch_scc1 k6_kernel_pd52
  s_waitcnt vmcnt(0)
  v_cmp_eq_u32 vcc, v2, v252
  s_cmp_eq_u64 vcc, -1
  s_cbranch_scc0 k6_kernel_L50
k6_kernel_pd52:
  s_cmp_eq_u32 s52, 0
  s_cbranch_scc1 k6_kernel_pr30
  buffer_inv sc1
  s_waitcnt vmcnt(0)
  s_branch k6_kernel_pr30
k6_kernel_pub31:
  buffer_wbl2 sc1
  s_waitcnt vmcnt(0)
  buffer_store_dword v2, off, s[8:11], s60 sc1
  s_branch k6_kernel_pb32
k6_kernel_pq33:
  s_mov_b32 s40, 0
k6_kernel_L52:
  buffer_load_dword v79, v10, s[8:11], s61 offen sc1
  s_add_u32 s40, s40, 1
  s_cmp_gt_u32 s40, 0x30d40
  s_cbranch_scc1 k6_kernel_pd54
  s_waitcnt vmcnt(0)
  v_cmp_eq_u32 vcc, v2, v79
  s_cmp_eq_u64 vcc, -1
  s_cbranch_scc0 k6_kernel_L52
k6_kernel_pd54:
  s_cmp_eq_u32 s52, 0
  s_cbranch_scc1 k6_kernel_pr34
  buffer_inv sc1
  s_waitcnt vmcnt(0)
  s_branch k6_kernel_pr34
k6_kernel_pq35:
  s_mov_b32 s40, 0
k6_kernel_L54:
  buffer_load_dword v26, v0, s[8:11], s62 offen sc1
  s_add_u32 s40, s40, 1
  s_cmp_gt_u32 s40, 0x30d40
  s_cbranch_scc1 k6_kernel_pd56
  s_waitcnt vmcnt(0)
  v_cmp_eq_u32 vcc, v2, v26
  s_cmp_eq_u64 vcc, -1
  s_cbranch_scc0 k6_kernel_L54
k6_kernel_pd56:
  s_cmp_eq_u32 s52, 0
  s_cbranch_scc1 k6_kernel_pr36
  buffer_inv sc1
  s_waitcnt vmcnt(0)
  s_branch k6_kernel_pr36
k6_kernel_pq37:
  s_mov_b32 s40, 0
k6_kernel_L56:
  buffer_load_dword v252, v0, s[8:11], s62 offen sc1
  s_add_u32 s40, s40, 1
  s_cmp_gt_u32 s40, 0x30d40
  s_cbranch_scc1 k6_kernel_pd58
  s_waitcnt vmcnt(0)
  v_cmp_eq_u32 vcc, v2, v252
  s_cmp_eq_u64 vcc, -1
  s_cbranch_scc0 k6_kernel_L56
k6_kernel_pd58:
  s_cmp_eq_u32 s52, 0
  s_cbranch_scc1 k6_kernel_pr38
  buffer_inv sc1
  s_waitcnt vmcnt(0)
  s_branch k6_kernel_pr38
k6_codeend:
k6_kernel_end1:
  s_endpgm
.section .rodata,"a"
.p2align 6
.amdhsa_kernel sequential_preLN__softmax_full_mha__dense_activation_relu__prompt_kernel
  .amdhsa_next_free_vgpr 256
  .amdhsa_next_free_sgpr 102
  .amdhsa_accum_offset 256
  .amdhsa_group_segment_fixed_size 0
  .amdhsa_kernarg_size 72
  .amdhsa_user_sgpr_count 2
  .amdhsa_user_sgpr_kernarg_segment_ptr 1
  .amdhsa_system_sgpr_workgroup_id_x 1
.end_amdhsa_kernel
```
